```python
import torch

def _softmax(x, axis=-1):
    return torch.softmax(x, dim=axis)
def _gelu(x):
    return torch.nn.functional.gelu(x, approximate="tanh")
def _silu(x):
    return torch.nn.functional.silu(x)
def _sigmoid(x):
    return torch.sigmoid(x)
def _layernorm(x, axis=-1, eps=1e-5):
    m = x.mean(dim=axis, keepdim=True)
    v = x.var(dim=axis, keepdim=True, unbiased=False)
    return (x - m) / torch.sqrt(v + eps)
def _scatter_add(tgt, idx, src, axis=0):
    return tgt.clone().index_add_(axis, idx, src)
def _segment_sum(src, seg, n):
    out = torch.zeros((n,) + src.shape[1:], dtype=src.dtype)
    return out.index_add_(0, seg, src)
def _pad(x, pw):
    flat = tuple(v for pair in reversed(pw) for v in pair)
    return torch.nn.functional.pad(x, flat)

kernel_name = 'standalone__self_sup_conv_stem_wavlm__speech'

def setup_inputs():

    _w = (lambda a: (lambda t: t.to(torch.bfloat16) if t.is_floating_point() else t)(torch.as_tensor(a)))
    B, T, D, K = 2, 16000, 144, 15
    scale = (K * D) ** -0.5
    return {
        "x": _w((lambda *s: torch.randn(*s, dtype=torch.bfloat16) * 0.05)(B, T, D)),
        "w": _w((lambda *s: torch.randn(*s, dtype=torch.bfloat16) * 0.05)(K, D, D) * scale),
        "gn_gamma": _w((lambda *s: torch.randn(*s, dtype=torch.bfloat16) * 0.05)(D) * 0.1 + 1.0),
        "gn_beta": _w((lambda *s: torch.randn(*s, dtype=torch.bfloat16) * 0.05)(D) * 0.1),
    }

def reference(x, w, gn_gamma, gn_beta):
    B, T, D = x.shape
    K = w.shape[0]
    s = 2
    L = (T - K) // s + 1
    h = torch.einsum('blc,cd->bld', x[:, 0:s * L:s, :], w[0])
    for i in range(1, K):
        h = h + torch.einsum('blc,cd->bld', x[:, i:i + s * L:s, :], w[i])
    mu = torch.einsum('bld->bd', h)[:, None, :] / L
    var = torch.einsum('bld->bd', (h - mu) ** 2)[:, None, :] / L
    h = (h - mu) / torch.sqrt(var + 1e-5)
    h = h * gn_gamma[None, None, :] + gn_beta[None, None, :]
    return _gelu(h)
```

```asm
; @launch grid=(256,1,1) block=(512,1,1) lds=163216
.amdgcn_target "amdgcn-amd-amdhsa--gfx950"
.text
.globl standalone__self_sup_conv_stem_wavlm__speech_kernel
.p2align 8
.type standalone__self_sup_conv_stem_wavlm__speech_kernel,@function
standalone__self_sup_conv_stem_wavlm__speech_kernel:
  s_load_dwordx8 s[4:11], s[0:1], 0
  s_load_dwordx4 s[12:15], s[0:1], 32
  s_load_dwordx2 s[16:17], s[0:1], 48
  s_cmp_ge_u32 s2, 256
  s_cbranch_scc1 L_end
  v_lshrrev_b32 v130, 6, v0
  v_and_b32 v129, 63, v0
  v_readfirstlane_b32 s18, v130
  s_and_b32 s3, s2, 7
  s_lshr_b32 s49, s2, 3
  s_lshl_b32 s46, s3, 1
  s_add_u32 s46, s46, s49
  s_sub_u32 s46, s46, 30
  s_mul_i32 s47, s3, 10
  s_cmp_lt_u32 s49, 30
  s_cselect_b32 s46, s49, s46
  s_cselect_b32 s47, s47, 80
  s_cselect_b32 s48, 0, s46
  s_cmp_ge_u32 s48, 12
  s_cbranch_scc1 L_end
  s_mul_i32 s48, s46, 43
  s_lshr_b32 s48, s48, 7
  s_add_u32 s19, s47, s48
  s_mul_i32 s48, s48, 3
  s_sub_u32 s20, s46, s48
  s_cmp_ge_u32 s19, 42
  s_cselect_b32 s21, 1, 0
  s_cselect_b32 s48, 42, 0
  s_cselect_b32 s23, 3, 0
  s_cselect_b32 s44, 4608000, 0
  s_sub_u32 s22, s19, s48
  s_add_u32 s23, s23, s20
  s_mul_i32 s45, s22, 110592
  s_add_u32 s44, s44, s45
  s_sub_u32 s26, 4607712, s45
  s_mov_b32 s27, 0x20000
  v_lshrrev_b32 v136, 4, v129
  v_lshrrev_b32 v132, 3, v129
  v_and_b32 v133, 2, v132
  v_and_b32 v134, 7, v129
  v_xor_b32 v133, v133, v134
  v_lshlrev_b32 v133, 4, v133
  v_mul_u32_u24 v131, 1152, v132
  v_add_u32 v131, v131, v133
  s_mul_i32 s43, s20, 96
  s_cmp_ge_u32 s18, 7
  s_cselect_b32 s48, 0, s18
  s_cmp_ge_u32 s48, 4
  s_cbranch_scc1 L_wpro
  s_add_u32 s46, s20, 1
  s_cmp_eq_u32 s46, 3
  s_cselect_b32 s46, 0, s46
  s_add_u32 s47, s20, s46
  s_sub_u32 s47, 3, s47
  s_lshl_b32 s92, s20, 10
  s_lshl_b32 s93, s46, 10
  s_lshl_b32 s94, s47, 10
  s_mul_i32 s95, s20, 9216
  s_mul_i32 s96, s46, 9216
  s_mul_i32 s97, s47, 9216
  s_cmp_eq_u32 s18, 7
  s_cbranch_scc1 L_xpro
  s_mul_i32 s46, s18, 3072
  s_mul_i32 s47, s18, 27648
  s_add_u32 s92, s92, s46
  s_add_u32 s95, s95, s47
  s_add_u32 s93, s93, s46
  s_add_u32 s96, s96, s47
  s_add_u32 s94, s94, s46
  s_add_u32 s97, s97, s47
  s_cmp_eq_u32 s18, 3
  s_cselect_b32 s46, 37888, s46
  s_cselect_b32 s47, 110848, s47
  s_cmp_eq_u32 s18, 2
  s_cselect_b32 s46, 89088, s46
  s_cselect_b32 s47, 111360, s47
  s_cmp_eq_u32 s18, 1
  s_cselect_b32 s46, 101888, s46
  s_cselect_b32 s47, 111488, s47
  s_waitcnt lgkmcnt(0)
  s_add_u32 s24, s4, s44
  s_addc_u32 s25, s5, 0
  s_add_u32 m0, s92, 25600
  s_add_u32 s50, s95, 256
  buffer_load_dwordx4 v131, s[24:27], s50 offen lds
  s_add_u32 m0, s92, 76800
  s_add_u32 s50, s95, 768
  buffer_load_dwordx4 v131, s[24:27], s50 offen lds
  s_cmp_lt_u32 s18, 1
  s_cbranch_scc1 L_c_nohalf
  s_mov_b32 m0, s46
  s_mov_b32 exec_hi, 0
  buffer_load_dwordx4 v131, s[24:27], s47 offen lds
  s_mov_b32 exec_hi, -1
L_c_nohalf:
  s_add_u32 m0, s92, 89600
  s_add_u32 s50, s95, 896
  buffer_load_dwordx4 v131, s[24:27], s50 offen lds
  s_add_u32 m0, s93, 25600
  s_add_u32 s50, s96, 256
  buffer_load_dwordx4 v131, s[24:27], s50 offen lds
  s_add_u32 m0, s93, 76800
  s_add_u32 s50, s96, 768
  buffer_load_dwordx4 v131, s[24:27], s50 offen lds
  s_add_u32 m0, s94, 25600
  s_add_u32 s50, s97, 256
  buffer_load_dwordx4 v131, s[24:27], s50 offen lds
  s_add_u32 m0, s94, 76800
  s_add_u32 s50, s97, 768
  buffer_load_dwordx4 v131, s[24:27], s50 offen lds
  s_branch L_cons
L_wpro:
  v_subrev_u32 v140, 256, v0
  v_mul_u32_u24 v141, 171, v140
  v_lshrrev_b32 v141, 10, v141
  v_mul_u32_u24 v142, 6, v141
  v_sub_u32 v142, v140, v142
  v_and_b32 v143, 0x13, v141
  v_and_b32 v144, 4, v141
  v_lshl_add_u32 v143, v144, 1, v143
  v_and_b32 v144, 8, v141
  v_lshrrev_b32 v144, 1, v144
  v_add_u32 v143, v143, v144
  v_mul_u32_u24 v143, 288, v143
  v_lshl_add_u32 v139, v142, 4, v143
  s_sub_u32 s49, s18, 4
  s_lshl_b32 s51, s49, 10
  s_sub_u32 s30, 622080, s43
  s_mov_b32 s31, 0x20000
  s_waitcnt lgkmcnt(0)
  s_add_u32 s28, s6, s43
  s_addc_u32 s29, s7, 0
  s_add_u32 m0, s51, 115200
  s_mov_b32 s50, 36864
  buffer_load_dwordx4 v139, s[28:31], s50 offen lds
  s_add_u32 m0, s51, 118272
  s_mov_b32 s50, 119808
  buffer_load_dwordx4 v139, s[28:31], s50 offen lds
  s_mov_b32 s92, s51
  s_mul_i32 s95, s49, 9216
  s_add_u32 s24, s4, s44
  s_addc_u32 s25, s5, 0
  v_and_b32 v135, 7, v129
  v_lshlrev_b32 v135, 1, v135
  v_lshrrev_b32 v134, 5, v129
  v_add_u32 v135, v135, v134
  s_lshl_b32 s44, s49, 4
  v_add_u32 v135, s44, v135
  v_lshlrev_b32 v134, 1, v135
  v_add_u32 v134, s43, v134
  s_mov_b32 s52, s8
  s_mov_b32 s53, s9
  s_mov_b32 s54, 288
  s_mov_b32 s55, 0x20000
  s_mov_b32 s56, s10
  s_mov_b32 s57, s11
  s_mov_b32 s58, 288
  s_mov_b32 s59, 0x20000
  s_lshl_b32 s44, s23, 14
  s_add_u32 s36, s16, s44
  s_addc_u32 s37, s17, 0
  s_mov_b32 s38, 16128
  s_mov_b32 s39, 0x20000
  s_cmp_eq_u32 s20, 1
  s_cbranch_scc1 L_wmain1
  s_cmp_eq_u32 s20, 2
  s_cbranch_scc1 L_wmain2
  s_branch L_wmain0
L_xpro:
  s_mov_b32 s30, 622080
  s_mov_b32 s31, 0x20000
  v_lshlrev_b32 v100, 8, v129
  v_add_u32 v100, s2, v100
  v_lshlrev_b32 v100, 7, v100
  v_lshl_add_u32 v141, v129, 5, s49
  v_mul_u32_u24 v142, 911, v141
  v_lshrrev_b32 v142, 16, v142
  v_mul_u32_u24 v143, 73728, v142
  v_lshl_add_u32 v143, v141, 7, v143
  v_add_u32 v101, 36864, v143
  s_waitcnt lgkmcnt(0)
  s_mov_b32 s28, s6
  s_mov_b32 s29, s7
  s_mov_b64 exec, 0x3ffff
  buffer_load_dword v146, v101, s[28:31], 0 offen
  s_mov_b64 exec, 0x7ffff
  buffer_load_dword v146, v100, s[28:31], 0 offen
  s_mov_b64 exec, -1
  s_add_u32 s24, s4, s44
  s_addc_u32 s25, s5, 0
  s_mov_b32 s80, s92
  s_mov_b32 s83, s95
  s_mov_b32 s81, s93
  s_mov_b32 s84, s96
  s_mov_b32 s82, s94
  s_mov_b32 s85, s97
  s_movk_i32 s92, 3072
  s_movk_i32 s95, 27648
  v_mov_b32 v140, 163200
  v_mov_b32 v40, 0
  v_mov_b32 v41, 0
  v_mov_b32 v42, 0
  v_mov_b32 v43, 0
  ds_write_b128 v140, v[40:43]
  s_waitcnt lgkmcnt(0)
  s_cmp_eq_u32 s20, 1
  s_cbranch_scc1 L_xmain1
  s_cmp_eq_u32 s20, 2
  s_cbranch_scc1 L_xmain2
  s_branch L_xmain0
L_cons:
  s_lshl_b32 s44, s23, 14
  s_add_u32 s36, s16, s44
  s_addc_u32 s37, s17, 0
  s_mov_b32 s38, 16128
  s_mov_b32 s39, 0x20000
  s_cmp_lg_u32 s18, 0
  s_cbranch_scc1 L_c_noclr
  v_lshlrev_b32 v142, 4, v129
  s_mul_i32 s50, s22, 384
  v_mov_b32 v40, -1
  v_mov_b32 v41, -1
  v_mov_b32 v42, -1
  v_mov_b32 v43, -1
  s_mov_b64 exec, 0xffffff
  buffer_store_dwordx4 v[40:43], v142, s[36:39], s50 offen sc1
  s_mov_b64 exec, -1
L_c_noclr:
  v_and_b32 v139, 15, v129
  v_mul_u32_u24 v140, 3, v139
  v_mul_u32_u24 v141, 48, v130
  v_add_u32 v140, v140, v141
  v_and_b32 v141, 1, v140
  v_lshrrev_b32 v142, 1, v140
  v_cmp_eq_u32 vcc, 1, v141
  v_and_b32 v143, 2, v142
  v_xor_b32 v143, v143, v136
  v_lshlrev_b32 v143, 4, v143
  v_lshl_add_u32 v100, v142, 7, v143
  v_add_u32 v142, 1, v142
  v_and_b32 v143, 2, v142
  v_xor_b32 v143, v143, v136
  v_lshlrev_b32 v143, 4, v143
  v_lshl_add_u32 v101, v142, 7, v143
  v_add_u32 v142, 1, v142
  v_and_b32 v143, 2, v142
  v_xor_b32 v143, v143, v136
  v_lshlrev_b32 v143, 4, v143
  v_lshl_add_u32 v102, v142, 7, v143
  v_add_u32 v142, 1, v142
  v_and_b32 v143, 2, v142
  v_xor_b32 v143, v143, v136
  v_lshlrev_b32 v143, 4, v143
  v_lshl_add_u32 v103, v142, 7, v143
  v_add_u32 v142, 1, v142
  v_and_b32 v143, 2, v142
  v_xor_b32 v143, v143, v136
  v_lshlrev_b32 v143, 4, v143
  v_lshl_add_u32 v104, v142, 7, v143
  v_mul_u32_u24 v105, 51264, v141
  v_sub_u32 v106, 51264, v105
  v_mul_u32_u24 v107, 63936, v141
  v_sub_u32 v108, 64000, v107
  v_add_u32 v107, 64, v107
  v_add_u32 v112, v100, v105
  v_add_u32 v120, v100, v107
  v_cndmask_b32 v143, v100, v101, vcc
  v_add_u32 v113, v143, v106
  v_add_u32 v121, v143, v108
  v_add_u32 v114, v101, v105
  v_add_u32 v122, v101, v107
  v_cndmask_b32 v143, v101, v102, vcc
  v_add_u32 v115, v143, v106
  v_add_u32 v123, v143, v108
  v_add_u32 v116, v102, v105
  v_add_u32 v124, v102, v107
  v_cndmask_b32 v143, v102, v103, vcc
  v_add_u32 v117, v143, v106
  v_add_u32 v125, v143, v108
  v_add_u32 v118, v103, v105
  v_add_u32 v126, v103, v107
  v_cndmask_b32 v143, v103, v104, vcc
  v_add_u32 v119, v143, v106
  v_add_u32 v127, v143, v108
  v_lshrrev_b32 v141, 1, v136
  v_lshlrev_b32 v141, 4, v141
  v_and_b32 v142, 1, v136
  v_lshl_add_u32 v141, v142, 2, v141
  v_bfe_u32 v142, v129, 2, 2
  v_add_u32 v141, v141, v142
  v_mul_u32_u24 v141, 96, v141
  v_and_b32 v142, 3, v129
  v_lshl_add_u32 v141, v142, 3, v141
  v_add_u32 v128, 115200, v141
  v_add_u32 v137, 12800, v141
  v_mul_u32_u24 v141, 384, v130
  v_and_b32 v143, 12, v139
  v_lshl_add_u32 v142, v136, 5, v143
  v_add_u32 v132, v141, v142
  v_add_u32 v132, 161280, v132
  v_lshlrev_b32 v133, 4, v136
  v_add_u32 v133, 162816, v133
  v_mov_b32 v134, 163200
  v_mul_u32_u24 v135, 288, v140
  v_lshl_add_u32 v135, v136, 3, v135
  v_mov_b32 v144, 0xc0135761
  v_mov_b32 v145, 0xc0135761
  v_mov_b32 v146, 0xbdd2d3e8
  v_mov_b32 v147, 0xbdd2d3e8
  v_mov_b32 v148, 1.0
  v_mov_b32 v149, 1.0
  s_mul_i32 s44, s21, 7993
  s_mul_i32 s45, s22, 192
  s_add_u32 s44, s44, s45
  s_mul_i32 s44, s44, 288
  s_add_u32 s44, s44, s43
  s_add_u32 s32, s12, s44
  s_addc_u32 s33, s13, 0
  s_sub_u32 s34, 7993, s45
  s_mul_i32 s34, s34, 288
  s_sub_u32 s34, s34, s43
  s_mov_b32 s35, 0x20000
  s_movk_i32 s46, 121
  v_cmp_le_u32 s[70:71], s46, v140
  s_movk_i32 s46, 120
  v_cmp_le_u32 s[72:73], s46, v140
  s_movk_i32 s46, 119
  v_cmp_le_u32 s[74:75], s46, v140
  s_lshl_b32 s44, s23, 5
  v_mov_b32 v141, s44
  v_mov_b32 v142, 1
  s_waitcnt vmcnt(1)
  s_cmp_eq_u32 s18, 0
  s_cbranch_scc1 L_c_p
  s_waitcnt vmcnt(0)
L_c_p:
  s_barrier
  ds_read_b128 v[36:39], v112 offset:25600
  ds_read_b128 v[40:43], v113 offset:25600
  ds_read_b128 v[44:47], v114 offset:25600
  ds_read_b64_tr_b16 v[208:209], v128 offset:0
  ds_read_b64_tr_b16 v[210:211], v128 offset:768
  ds_read_b64_tr_b16 v[212:213], v128 offset:32
  ds_read_b64_tr_b16 v[214:215], v128 offset:800
  ds_read_b64_tr_b16 v[216:217], v128 offset:64
  ds_read_b64_tr_b16 v[218:219], v128 offset:832
  s_waitcnt lgkmcnt(4)
  s_barrier
  v_mfma_f32_16x16x32_bf16 v[0:3], v[208:211], v[36:39], 0
  ds_read_b128 v[48:51], v115 offset:25600
  ds_read_b128 v[52:55], v116 offset:25600
  v_mfma_f32_16x16x32_bf16 v[12:15], v[208:211], v[40:43], 0
  ds_read_b64_tr_b16 v[232:233], v128 offset:3072
  ds_read_b64_tr_b16 v[234:235], v128 offset:3840
  v_mfma_f32_16x16x32_bf16 v[24:27], v[208:211], v[44:47], 0
  ds_read_b64_tr_b16 v[244:245], v128 offset:6144
  ds_read_b64_tr_b16 v[246:247], v128 offset:6912
  s_waitcnt lgkmcnt(8)
  v_mfma_f32_16x16x32_bf16 v[28:31], v[212:215], v[44:47], 0
  ds_read_b64_tr_b16 v[248:249], v128 offset:6176
  ds_read_b64_tr_b16 v[250:251], v128 offset:6944
  v_mfma_f32_16x16x32_bf16 v[16:19], v[212:215], v[40:43], 0
  ds_read_b64_tr_b16 v[236:237], v128 offset:3104
  ds_read_b64_tr_b16 v[238:239], v128 offset:3872
  v_mfma_f32_16x16x32_bf16 v[4:7], v[212:215], v[36:39], 0
  ds_read_b64_tr_b16 v[240:241], v128 offset:3136
  ds_read_b64_tr_b16 v[242:243], v128 offset:3904
  s_waitcnt lgkmcnt(12)
  v_mfma_f32_16x16x32_bf16 v[8:11], v[216:219], v[36:39], 0
  ds_read_b64_tr_b16 v[252:253], v128 offset:6208
  ds_read_b64_tr_b16 v[254:255], v128 offset:6976
  v_mfma_f32_16x16x32_bf16 v[20:23], v[216:219], v[40:43], 0
  v_mfma_f32_16x16x32_bf16 v[32:35], v[216:219], v[44:47], 0
  s_waitcnt lgkmcnt(8)
  s_barrier
  v_mfma_f32_16x16x32_bf16 v[0:3], v[232:235], v[40:43], v[0:3]
  ds_read_b128 v[56:59], v117 offset:25600
  v_mfma_f32_16x16x32_bf16 v[0:3], v[244:247], v[44:47], v[0:3]
  ds_read_b128 v[60:63], v118 offset:25600
  v_mfma_f32_16x16x32_bf16 v[12:15], v[244:247], v[48:51], v[12:15]
  ds_read_b64_tr_b16 v[208:209], v128 offset:9216
  v_mfma_f32_16x16x32_bf16 v[12:15], v[232:235], v[44:47], v[12:15]
  ds_read_b64_tr_b16 v[210:211], v128 offset:9984
  v_mfma_f32_16x16x32_bf16 v[24:27], v[232:235], v[48:51], v[24:27]
  ds_read_b64_tr_b16 v[220:221], v128 offset:12288
  v_mfma_f32_16x16x32_bf16 v[24:27], v[244:247], v[52:55], v[24:27]
  ds_read_b64_tr_b16 v[222:223], v128 offset:13056
  s_waitcnt lgkmcnt(10)
  v_mfma_f32_16x16x32_bf16 v[28:31], v[248:251], v[52:55], v[28:31]
  ds_read_b64_tr_b16 v[224:225], v128 offset:12320
  v_mfma_f32_16x16x32_bf16 v[28:31], v[236:239], v[48:51], v[28:31]
  ds_read_b64_tr_b16 v[226:227], v128 offset:13088
  v_mfma_f32_16x16x32_bf16 v[16:19], v[236:239], v[44:47], v[16:19]
  ds_read_b64_tr_b16 v[212:213], v128 offset:9248
  v_mfma_f32_16x16x32_bf16 v[16:19], v[248:251], v[48:51], v[16:19]
  ds_read_b64_tr_b16 v[214:215], v128 offset:10016
  v_mfma_f32_16x16x32_bf16 v[4:7], v[248:251], v[44:47], v[4:7]
  ds_read_b64_tr_b16 v[216:217], v128 offset:9280
  v_mfma_f32_16x16x32_bf16 v[4:7], v[236:239], v[40:43], v[4:7]
  ds_read_b64_tr_b16 v[218:219], v128 offset:10048
  s_waitcnt lgkmcnt(12)
  v_mfma_f32_16x16x32_bf16 v[8:11], v[240:243], v[40:43], v[8:11]
  ds_read_b64_tr_b16 v[228:229], v128 offset:12352
  v_mfma_f32_16x16x32_bf16 v[8:11], v[252:255], v[44:47], v[8:11]
  ds_read_b64_tr_b16 v[230:231], v128 offset:13120
  v_mfma_f32_16x16x32_bf16 v[20:23], v[252:255], v[48:51], v[20:23]
  v_mfma_f32_16x16x32_bf16 v[20:23], v[240:243], v[44:47], v[20:23]
  v_mfma_f32_16x16x32_bf16 v[32:35], v[240:243], v[48:51], v[32:35]
  v_mfma_f32_16x16x32_bf16 v[32:35], v[252:255], v[52:55], v[32:35]
  s_waitcnt lgkmcnt(8)
  s_barrier
  v_mfma_f32_16x16x32_bf16 v[0:3], v[208:211], v[48:51], v[0:3]
  ds_read_b128 v[64:67], v119 offset:25600
  v_mfma_f32_16x16x32_bf16 v[0:3], v[220:223], v[52:55], v[0:3]
  ds_read_b128 v[68:71], v112 offset:26112
  v_mfma_f32_16x16x32_bf16 v[12:15], v[220:223], v[56:59], v[12:15]
  ds_read_b64_tr_b16 v[232:233], v128 offset:15360
  v_mfma_f32_16x16x32_bf16 v[12:15], v[208:211], v[52:55], v[12:15]
  ds_read_b64_tr_b16 v[234:235], v128 offset:16128
  v_mfma_f32_16x16x32_bf16 v[24:27], v[208:211], v[56:59], v[24:27]
  ds_read_b64_tr_b16 v[244:245], v128 offset:18432
  v_mfma_f32_16x16x32_bf16 v[24:27], v[220:223], v[60:63], v[24:27]
  ds_read_b64_tr_b16 v[246:247], v128 offset:19200
  s_waitcnt lgkmcnt(10)
  v_mfma_f32_16x16x32_bf16 v[28:31], v[224:227], v[60:63], v[28:31]
  ds_read_b64_tr_b16 v[248:249], v128 offset:18464
  v_mfma_f32_16x16x32_bf16 v[28:31], v[212:215], v[56:59], v[28:31]
  ds_read_b64_tr_b16 v[250:251], v128 offset:19232
  v_mfma_f32_16x16x32_bf16 v[16:19], v[212:215], v[52:55], v[16:19]
  ds_read_b64_tr_b16 v[236:237], v128 offset:15392
  v_mfma_f32_16x16x32_bf16 v[16:19], v[224:227], v[56:59], v[16:19]
  ds_read_b64_tr_b16 v[238:239], v128 offset:16160
  v_mfma_f32_16x16x32_bf16 v[4:7], v[224:227], v[52:55], v[4:7]
  ds_read_b64_tr_b16 v[240:241], v128 offset:15424
  v_mfma_f32_16x16x32_bf16 v[4:7], v[212:215], v[48:51], v[4:7]
  ds_read_b64_tr_b16 v[242:243], v128 offset:16192
  s_waitcnt lgkmcnt(12)
  v_mfma_f32_16x16x32_bf16 v[8:11], v[216:219], v[48:51], v[8:11]
  ds_read_b64_tr_b16 v[252:253], v128 offset:18496
  v_mfma_f32_16x16x32_bf16 v[8:11], v[228:231], v[52:55], v[8:11]
  ds_read_b64_tr_b16 v[254:255], v128 offset:19264
  v_mfma_f32_16x16x32_bf16 v[20:23], v[228:231], v[56:59], v[20:23]
  v_mfma_f32_16x16x32_bf16 v[20:23], v[216:219], v[52:55], v[20:23]
  v_mfma_f32_16x16x32_bf16 v[32:35], v[216:219], v[56:59], v[32:35]
  v_mfma_f32_16x16x32_bf16 v[32:35], v[228:231], v[60:63], v[32:35]
  s_waitcnt lgkmcnt(8)
  s_barrier
  v_mfma_f32_16x16x32_bf16 v[0:3], v[232:235], v[56:59], v[0:3]
  ds_read_b128 v[72:75], v113 offset:26112
  v_mfma_f32_16x16x32_bf16 v[0:3], v[244:247], v[60:63], v[0:3]
  ds_read_b128 v[36:39], v120 offset:25600
  v_mfma_f32_16x16x32_bf16 v[12:15], v[244:247], v[64:67], v[12:15]
  ds_read_b128 v[40:43], v121 offset:25600
  v_mfma_f32_16x16x32_bf16 v[12:15], v[232:235], v[60:63], v[12:15]
  ds_read_b128 v[44:47], v122 offset:25600
  v_mfma_f32_16x16x32_bf16 v[24:27], v[232:235], v[64:67], v[24:27]
  ds_read_b64_tr_b16 v[208:209], v128 offset:21504
  v_mfma_f32_16x16x32_bf16 v[24:27], v[244:247], v[68:71], v[24:27]
  ds_read_b64_tr_b16 v[210:211], v128 offset:22272
  s_waitcnt lgkmcnt(10)
  v_mfma_f32_16x16x32_bf16 v[28:31], v[248:251], v[68:71], v[28:31]
  ds_read_b64_tr_b16 v[220:221], v128 offset:24576
  v_mfma_f32_16x16x32_bf16 v[28:31], v[236:239], v[64:67], v[28:31]
  ds_read_b64_tr_b16 v[222:223], v128 offset:25344
  v_mfma_f32_16x16x32_bf16 v[16:19], v[236:239], v[60:63], v[16:19]
  ds_read_b64_tr_b16 v[224:225], v128 offset:24608
  v_mfma_f32_16x16x32_bf16 v[16:19], v[248:251], v[64:67], v[16:19]
  ds_read_b64_tr_b16 v[226:227], v128 offset:25376
  v_mfma_f32_16x16x32_bf16 v[4:7], v[248:251], v[60:63], v[4:7]
  ds_read_b64_tr_b16 v[212:213], v128 offset:21536
  v_mfma_f32_16x16x32_bf16 v[4:7], v[236:239], v[56:59], v[4:7]
  ds_read_b64_tr_b16 v[214:215], v128 offset:22304
  s_waitcnt lgkmcnt(12)
  v_mfma_f32_16x16x32_bf16 v[8:11], v[240:243], v[56:59], v[8:11]
  ds_read_b64_tr_b16 v[216:217], v128 offset:21568
  v_mfma_f32_16x16x32_bf16 v[8:11], v[252:255], v[60:63], v[8:11]
  ds_read_b64_tr_b16 v[218:219], v128 offset:22336
  v_mfma_f32_16x16x32_bf16 v[20:23], v[252:255], v[64:67], v[20:23]
  ds_read_b64_tr_b16 v[228:229], v128 offset:24640
  v_mfma_f32_16x16x32_bf16 v[20:23], v[240:243], v[60:63], v[20:23]
  ds_read_b64_tr_b16 v[230:231], v128 offset:25408
  v_mfma_f32_16x16x32_bf16 v[32:35], v[240:243], v[64:67], v[32:35]
  v_mfma_f32_16x16x32_bf16 v[32:35], v[252:255], v[68:71], v[32:35]
  s_waitcnt lgkmcnt(8)
  s_barrier
  v_mfma_f32_16x16x32_bf16 v[0:3], v[208:211], v[64:67], v[0:3]
  ds_read_b128 v[48:51], v123 offset:25600
  v_mfma_f32_16x16x32_bf16 v[0:3], v[220:223], v[36:39], v[0:3]
  ds_read_b128 v[52:55], v124 offset:25600
  v_mfma_f32_16x16x32_bf16 v[12:15], v[220:223], v[40:43], v[12:15]
  ds_read_b64_tr_b16 v[232:233], v128 offset:27648
  v_mfma_f32_16x16x32_bf16 v[12:15], v[208:211], v[68:71], v[12:15]
  ds_read_b64_tr_b16 v[234:235], v128 offset:28416
  v_mfma_f32_16x16x32_bf16 v[24:27], v[208:211], v[72:75], v[24:27]
  ds_read_b64_tr_b16 v[244:245], v128 offset:30720
  v_mfma_f32_16x16x32_bf16 v[24:27], v[220:223], v[44:47], v[24:27]
  ds_read_b64_tr_b16 v[246:247], v128 offset:31488
  s_waitcnt lgkmcnt(10)
  v_mfma_f32_16x16x32_bf16 v[28:31], v[224:227], v[44:47], v[28:31]
  ds_read_b64_tr_b16 v[248:249], v128 offset:30752
  v_mfma_f32_16x16x32_bf16 v[28:31], v[212:215], v[72:75], v[28:31]
  ds_read_b64_tr_b16 v[250:251], v128 offset:31520
  v_mfma_f32_16x16x32_bf16 v[16:19], v[212:215], v[68:71], v[16:19]
  ds_read_b64_tr_b16 v[236:237], v128 offset:27680
  v_mfma_f32_16x16x32_bf16 v[16:19], v[224:227], v[40:43], v[16:19]
  ds_read_b64_tr_b16 v[238:239], v128 offset:28448
  v_mfma_f32_16x16x32_bf16 v[4:7], v[224:227], v[36:39], v[4:7]
  ds_read_b64_tr_b16 v[240:241], v128 offset:27712
  v_mfma_f32_16x16x32_bf16 v[4:7], v[212:215], v[64:67], v[4:7]
  ds_read_b64_tr_b16 v[242:243], v128 offset:28480
  s_waitcnt lgkmcnt(12)
  v_mfma_f32_16x16x32_bf16 v[8:11], v[216:219], v[64:67], v[8:11]
  ds_read_b64_tr_b16 v[252:253], v128 offset:30784
  v_mfma_f32_16x16x32_bf16 v[8:11], v[228:231], v[36:39], v[8:11]
  ds_read_b64_tr_b16 v[254:255], v128 offset:31552
  v_mfma_f32_16x16x32_bf16 v[20:23], v[228:231], v[40:43], v[20:23]
  v_mfma_f32_16x16x32_bf16 v[20:23], v[216:219], v[68:71], v[20:23]
  v_mfma_f32_16x16x32_bf16 v[32:35], v[216:219], v[72:75], v[32:35]
  v_mfma_f32_16x16x32_bf16 v[32:35], v[228:231], v[44:47], v[32:35]
  s_cmp_lg_u32 s18, 0
  s_cbranch_scc1 L_c_noatom
  s_waitcnt vmcnt(0)
  s_mov_b64 exec, 1
  global_atomic_add v141, v142, s[14:15]
  s_mov_b64 exec, -1
L_c_noatom:
  s_waitcnt lgkmcnt(8)
  s_barrier
  v_mfma_f32_16x16x32_bf16 v[0:3], v[232:235], v[40:43], v[0:3]
  ds_read_b128 v[56:59], v125 offset:25600
  v_mfma_f32_16x16x32_bf16 v[0:3], v[244:247], v[44:47], v[0:3]
  ds_read_b128 v[60:63], v126 offset:25600
  v_mfma_f32_16x16x32_bf16 v[12:15], v[244:247], v[48:51], v[12:15]
  ds_read_b64_tr_b16 v[208:209], v128 offset:33792
  v_mfma_f32_16x16x32_bf16 v[12:15], v[232:235], v[44:47], v[12:15]
  ds_read_b64_tr_b16 v[210:211], v128 offset:34560
  v_mfma_f32_16x16x32_bf16 v[24:27], v[232:235], v[48:51], v[24:27]
  ds_read_b64_tr_b16 v[220:221], v128 offset:36864
  v_mfma_f32_16x16x32_bf16 v[24:27], v[244:247], v[52:55], v[24:27]
  ds_read_b64_tr_b16 v[222:223], v128 offset:37632
  s_waitcnt lgkmcnt(10)
  v_mfma_f32_16x16x32_bf16 v[28:31], v[248:251], v[52:55], v[28:31]
  ds_read_b64_tr_b16 v[224:225], v128 offset:36896
  v_mfma_f32_16x16x32_bf16 v[28:31], v[236:239], v[48:51], v[28:31]
  ds_read_b64_tr_b16 v[226:227], v128 offset:37664
  v_mfma_f32_16x16x32_bf16 v[16:19], v[236:239], v[44:47], v[16:19]
  ds_read_b64_tr_b16 v[212:213], v128 offset:33824
  v_mfma_f32_16x16x32_bf16 v[16:19], v[248:251], v[48:51], v[16:19]
  ds_read_b64_tr_b16 v[214:215], v128 offset:34592
  v_mfma_f32_16x16x32_bf16 v[4:7], v[248:251], v[44:47], v[4:7]
  ds_read_b64_tr_b16 v[216:217], v128 offset:33856
  v_mfma_f32_16x16x32_bf16 v[4:7], v[236:239], v[40:43], v[4:7]
  ds_read_b64_tr_b16 v[218:219], v128 offset:34624
  s_waitcnt lgkmcnt(12)
  v_mfma_f32_16x16x32_bf16 v[8:11], v[240:243], v[40:43], v[8:11]
  ds_read_b64_tr_b16 v[228:229], v128 offset:36928
  v_mfma_f32_16x16x32_bf16 v[8:11], v[252:255], v[44:47], v[8:11]
  ds_read_b64_tr_b16 v[230:231], v128 offset:37696
  v_mfma_f32_16x16x32_bf16 v[20:23], v[252:255], v[48:51], v[20:23]
  v_mfma_f32_16x16x32_bf16 v[20:23], v[240:243], v[44:47], v[20:23]
  v_mfma_f32_16x16x32_bf16 v[32:35], v[240:243], v[48:51], v[32:35]
  v_mfma_f32_16x16x32_bf16 v[32:35], v[252:255], v[52:55], v[32:35]
  s_waitcnt lgkmcnt(8)
  s_barrier
  v_mfma_f32_16x16x32_bf16 v[0:3], v[208:211], v[48:51], v[0:3]
  ds_read_b128 v[64:67], v127 offset:25600
  v_mfma_f32_16x16x32_bf16 v[0:3], v[220:223], v[52:55], v[0:3]
  ds_read_b128 v[68:71], v120 offset:26112
  v_mfma_f32_16x16x32_bf16 v[12:15], v[220:223], v[56:59], v[12:15]
  ds_read_b64_tr_b16 v[232:233], v128 offset:39936
  v_mfma_f32_16x16x32_bf16 v[12:15], v[208:211], v[52:55], v[12:15]
  ds_read_b64_tr_b16 v[234:235], v128 offset:40704
  v_mfma_f32_16x16x32_bf16 v[24:27], v[208:211], v[56:59], v[24:27]
  ds_read_b64_tr_b16 v[244:245], v128 offset:43008
  v_mfma_f32_16x16x32_bf16 v[24:27], v[220:223], v[60:63], v[24:27]
  ds_read_b64_tr_b16 v[246:247], v128 offset:43776
  s_waitcnt lgkmcnt(10)
  v_mfma_f32_16x16x32_bf16 v[28:31], v[224:227], v[60:63], v[28:31]
  ds_read_b64_tr_b16 v[248:249], v128 offset:43040
  v_mfma_f32_16x16x32_bf16 v[28:31], v[212:215], v[56:59], v[28:31]
  ds_read_b64_tr_b16 v[250:251], v128 offset:43808
  v_mfma_f32_16x16x32_bf16 v[16:19], v[212:215], v[52:55], v[16:19]
  ds_read_b64_tr_b16 v[236:237], v128 offset:39968
  v_mfma_f32_16x16x32_bf16 v[16:19], v[224:227], v[56:59], v[16:19]
  ds_read_b64_tr_b16 v[238:239], v128 offset:40736
  v_mfma_f32_16x16x32_bf16 v[4:7], v[224:227], v[52:55], v[4:7]
  ds_read_b64_tr_b16 v[240:241], v128 offset:40000
  v_mfma_f32_16x16x32_bf16 v[4:7], v[212:215], v[48:51], v[4:7]
  ds_read_b64_tr_b16 v[242:243], v128 offset:40768
  s_waitcnt lgkmcnt(12)
  v_mfma_f32_16x16x32_bf16 v[8:11], v[216:219], v[48:51], v[8:11]
  ds_read_b64_tr_b16 v[252:253], v128 offset:43072
  v_mfma_f32_16x16x32_bf16 v[8:11], v[228:231], v[52:55], v[8:11]
  ds_read_b64_tr_b16 v[254:255], v128 offset:43840
  v_mfma_f32_16x16x32_bf16 v[20:23], v[228:231], v[56:59], v[20:23]
  v_mfma_f32_16x16x32_bf16 v[20:23], v[216:219], v[52:55], v[20:23]
  v_mfma_f32_16x16x32_bf16 v[32:35], v[216:219], v[56:59], v[32:35]
  v_mfma_f32_16x16x32_bf16 v[32:35], v[228:231], v[60:63], v[32:35]
  s_waitcnt lgkmcnt(8)
  s_barrier
  v_mfma_f32_16x16x32_bf16 v[0:3], v[232:235], v[56:59], v[0:3]
  ds_read_b128 v[36:39], v120 offset:12800
  v_mfma_f32_16x16x32_bf16 v[0:3], v[244:247], v[60:63], v[0:3]
  ds_read_b128 v[40:43], v121 offset:12800
  v_mfma_f32_16x16x32_bf16 v[12:15], v[244:247], v[64:67], v[12:15]
  ds_read_b128 v[44:47], v122 offset:12800
  v_mfma_f32_16x16x32_bf16 v[12:15], v[232:235], v[60:63], v[12:15]
  ds_read_b128 v[48:51], v123 offset:12800
  v_mfma_f32_16x16x32_bf16 v[24:27], v[232:235], v[64:67], v[24:27]
  ds_read_b64_tr_b16 v[208:209], v128 offset:0
  v_mfma_f32_16x16x32_bf16 v[24:27], v[244:247], v[68:71], v[24:27]
  ds_read_b64_tr_b16 v[210:211], v128 offset:768
  s_waitcnt lgkmcnt(10)
  v_mfma_f32_16x16x32_bf16 v[28:31], v[248:251], v[68:71], v[28:31]
  ds_read_b64_tr_b16 v[220:221], v128 offset:3072
  v_mfma_f32_16x16x32_bf16 v[28:31], v[236:239], v[64:67], v[28:31]
  ds_read_b64_tr_b16 v[222:223], v128 offset:3840
  v_mfma_f32_16x16x32_bf16 v[16:19], v[236:239], v[60:63], v[16:19]
  ds_read_b64_tr_b16 v[224:225], v128 offset:3104
  v_mfma_f32_16x16x32_bf16 v[16:19], v[248:251], v[64:67], v[16:19]
  ds_read_b64_tr_b16 v[226:227], v128 offset:3872
  v_mfma_f32_16x16x32_bf16 v[4:7], v[248:251], v[60:63], v[4:7]
  ds_read_b64_tr_b16 v[212:213], v128 offset:32
  v_mfma_f32_16x16x32_bf16 v[4:7], v[236:239], v[56:59], v[4:7]
  ds_read_b64_tr_b16 v[214:215], v128 offset:800
  s_waitcnt lgkmcnt(12)
  v_mfma_f32_16x16x32_bf16 v[8:11], v[240:243], v[56:59], v[8:11]
  ds_read_b64_tr_b16 v[216:217], v128 offset:64
  v_mfma_f32_16x16x32_bf16 v[8:11], v[252:255], v[60:63], v[8:11]
  ds_read_b64_tr_b16 v[218:219], v128 offset:832
  v_mfma_f32_16x16x32_bf16 v[20:23], v[252:255], v[64:67], v[20:23]
  ds_read_b64_tr_b16 v[228:229], v128 offset:3136
  v_mfma_f32_16x16x32_bf16 v[20:23], v[240:243], v[60:63], v[20:23]
  ds_read_b64_tr_b16 v[230:231], v128 offset:3904
  v_mfma_f32_16x16x32_bf16 v[32:35], v[240:243], v[64:67], v[32:35]
  v_mfma_f32_16x16x32_bf16 v[32:35], v[252:255], v[68:71], v[32:35]
  s_waitcnt lgkmcnt(8)
  s_barrier
  v_mfma_f32_16x16x32_bf16 v[0:3], v[208:211], v[36:39], v[0:3]
  ds_read_b128 v[52:55], v124 offset:12800
  v_mfma_f32_16x16x32_bf16 v[0:3], v[220:223], v[40:43], v[0:3]
  ds_read_b128 v[56:59], v125 offset:12800
  v_mfma_f32_16x16x32_bf16 v[12:15], v[220:223], v[44:47], v[12:15]
  ds_read_b64_tr_b16 v[232:233], v128 offset:6144
  v_mfma_f32_16x16x32_bf16 v[12:15], v[208:211], v[40:43], v[12:15]
  ds_read_b64_tr_b16 v[234:235], v128 offset:6912
  v_mfma_f32_16x16x32_bf16 v[24:27], v[208:211], v[44:47], v[24:27]
  ds_read_b64_tr_b16 v[244:245], v128 offset:9216
  v_mfma_f32_16x16x32_bf16 v[24:27], v[220:223], v[48:51], v[24:27]
  ds_read_b64_tr_b16 v[246:247], v128 offset:9984
  s_waitcnt lgkmcnt(10)
  v_mfma_f32_16x16x32_bf16 v[28:31], v[224:227], v[48:51], v[28:31]
  ds_read_b64_tr_b16 v[248:249], v128 offset:9248
  v_mfma_f32_16x16x32_bf16 v[28:31], v[212:215], v[44:47], v[28:31]
  ds_read_b64_tr_b16 v[250:251], v128 offset:10016
  v_mfma_f32_16x16x32_bf16 v[16:19], v[212:215], v[40:43], v[16:19]
  ds_read_b64_tr_b16 v[236:237], v128 offset:6176
  v_mfma_f32_16x16x32_bf16 v[16:19], v[224:227], v[44:47], v[16:19]
  ds_read_b64_tr_b16 v[238:239], v128 offset:6944
  v_mfma_f32_16x16x32_bf16 v[4:7], v[224:227], v[40:43], v[4:7]
  ds_read_b64_tr_b16 v[240:241], v128 offset:6208
  v_mfma_f32_16x16x32_bf16 v[4:7], v[212:215], v[36:39], v[4:7]
  ds_read_b64_tr_b16 v[242:243], v128 offset:6976
  s_waitcnt lgkmcnt(12)
  v_mfma_f32_16x16x32_bf16 v[8:11], v[216:219], v[36:39], v[8:11]
  ds_read_b64_tr_b16 v[252:253], v128 offset:9280
  v_mfma_f32_16x16x32_bf16 v[8:11], v[228:231], v[40:43], v[8:11]
  ds_read_b64_tr_b16 v[254:255], v128 offset:10048
  v_mfma_f32_16x16x32_bf16 v[20:23], v[228:231], v[44:47], v[20:23]
  v_mfma_f32_16x16x32_bf16 v[20:23], v[216:219], v[40:43], v[20:23]
  v_mfma_f32_16x16x32_bf16 v[32:35], v[216:219], v[44:47], v[32:35]
  v_mfma_f32_16x16x32_bf16 v[32:35], v[228:231], v[48:51], v[32:35]
  s_waitcnt lgkmcnt(8)
  s_barrier
  v_mfma_f32_16x16x32_bf16 v[0:3], v[232:235], v[44:47], v[0:3]
  ds_read_b128 v[60:63], v126 offset:12800
  v_mfma_f32_16x16x32_bf16 v[0:3], v[244:247], v[48:51], v[0:3]
  ds_read_b128 v[64:67], v127 offset:12800
  v_mfma_f32_16x16x32_bf16 v[12:15], v[244:247], v[52:55], v[12:15]
  ds_read_b64_tr_b16 v[208:209], v128 offset:12288
  v_mfma_f32_16x16x32_bf16 v[12:15], v[232:235], v[48:51], v[12:15]
  ds_read_b64_tr_b16 v[210:211], v128 offset:13056
  v_mfma_f32_16x16x32_bf16 v[24:27], v[232:235], v[52:55], v[24:27]
  ds_read_b64_tr_b16 v[220:221], v128 offset:15360
  v_mfma_f32_16x16x32_bf16 v[24:27], v[244:247], v[56:59], v[24:27]
  ds_read_b64_tr_b16 v[222:223], v128 offset:16128
  s_waitcnt lgkmcnt(10)
  v_mfma_f32_16x16x32_bf16 v[28:31], v[248:251], v[56:59], v[28:31]
  ds_read_b64_tr_b16 v[224:225], v128 offset:15392
  v_mfma_f32_16x16x32_bf16 v[28:31], v[236:239], v[52:55], v[28:31]
  ds_read_b64_tr_b16 v[226:227], v128 offset:16160
  v_mfma_f32_16x16x32_bf16 v[16:19], v[236:239], v[48:51], v[16:19]
  ds_read_b64_tr_b16 v[212:213], v128 offset:12320
  v_mfma_f32_16x16x32_bf16 v[16:19], v[248:251], v[52:55], v[16:19]
  ds_read_b64_tr_b16 v[214:215], v128 offset:13088
  v_mfma_f32_16x16x32_bf16 v[4:7], v[248:251], v[48:51], v[4:7]
  ds_read_b64_tr_b16 v[216:217], v128 offset:12352
  v_mfma_f32_16x16x32_bf16 v[4:7], v[236:239], v[44:47], v[4:7]
  ds_read_b64_tr_b16 v[218:219], v128 offset:13120
  s_waitcnt lgkmcnt(12)
  v_mfma_f32_16x16x32_bf16 v[8:11], v[240:243], v[44:47], v[8:11]
  ds_read_b64_tr_b16 v[228:229], v128 offset:15424
  v_mfma_f32_16x16x32_bf16 v[8:11], v[252:255], v[48:51], v[8:11]
  ds_read_b64_tr_b16 v[230:231], v128 offset:16192
  v_mfma_f32_16x16x32_bf16 v[20:23], v[252:255], v[52:55], v[20:23]
  v_mfma_f32_16x16x32_bf16 v[20:23], v[240:243], v[48:51], v[20:23]
  v_mfma_f32_16x16x32_bf16 v[32:35], v[240:243], v[52:55], v[32:35]
  v_mfma_f32_16x16x32_bf16 v[32:35], v[252:255], v[56:59], v[32:35]
  s_waitcnt lgkmcnt(8)
  s_barrier
  v_mfma_f32_16x16x32_bf16 v[0:3], v[208:211], v[52:55], v[0:3]
  ds_read_b128 v[68:71], v120 offset:13312
  v_mfma_f32_16x16x32_bf16 v[0:3], v[220:223], v[56:59], v[0:3]
  ds_read_b128 v[72:75], v121 offset:13312
  v_mfma_f32_16x16x32_bf16 v[12:15], v[220:223], v[60:63], v[12:15]
  ds_read_b64_tr_b16 v[232:233], v128 offset:18432
  v_mfma_f32_16x16x32_bf16 v[12:15], v[208:211], v[56:59], v[12:15]
  ds_read_b64_tr_b16 v[234:235], v128 offset:19200
  v_mfma_f32_16x16x32_bf16 v[24:27], v[208:211], v[60:63], v[24:27]
  ds_read_b64_tr_b16 v[244:245], v128 offset:21504
  v_mfma_f32_16x16x32_bf16 v[24:27], v[220:223], v[64:67], v[24:27]
  ds_read_b64_tr_b16 v[246:247], v128 offset:22272
  s_waitcnt lgkmcnt(10)
  v_mfma_f32_16x16x32_bf16 v[28:31], v[224:227], v[64:67], v[28:31]
  ds_read_b64_tr_b16 v[248:249], v128 offset:21536
  v_mfma_f32_16x16x32_bf16 v[28:31], v[212:215], v[60:63], v[28:31]
  ds_read_b64_tr_b16 v[250:251], v128 offset:22304
  v_mfma_f32_16x16x32_bf16 v[16:19], v[212:215], v[56:59], v[16:19]
  ds_read_b64_tr_b16 v[236:237], v128 offset:18464
  v_mfma_f32_16x16x32_bf16 v[16:19], v[224:227], v[60:63], v[16:19]
  ds_read_b64_tr_b16 v[238:239], v128 offset:19232
  v_mfma_f32_16x16x32_bf16 v[4:7], v[224:227], v[56:59], v[4:7]
  ds_read_b64_tr_b16 v[240:241], v128 offset:18496
  v_mfma_f32_16x16x32_bf16 v[4:7], v[212:215], v[52:55], v[4:7]
  ds_read_b64_tr_b16 v[242:243], v128 offset:19264
  s_waitcnt lgkmcnt(12)
  v_mfma_f32_16x16x32_bf16 v[8:11], v[216:219], v[52:55], v[8:11]
  ds_read_b64_tr_b16 v[252:253], v128 offset:21568
  v_mfma_f32_16x16x32_bf16 v[8:11], v[228:231], v[56:59], v[8:11]
  ds_read_b64_tr_b16 v[254:255], v128 offset:22336
  v_mfma_f32_16x16x32_bf16 v[20:23], v[228:231], v[60:63], v[20:23]
  v_mfma_f32_16x16x32_bf16 v[20:23], v[216:219], v[56:59], v[20:23]
  v_mfma_f32_16x16x32_bf16 v[32:35], v[216:219], v[60:63], v[32:35]
  v_mfma_f32_16x16x32_bf16 v[32:35], v[228:231], v[64:67], v[32:35]
  s_waitcnt lgkmcnt(8)
  s_barrier
  v_mfma_f32_16x16x32_bf16 v[0:3], v[232:235], v[60:63], v[0:3]
  ds_read_b128 v[36:39], v112 offset:38400
  v_mfma_f32_16x16x32_bf16 v[0:3], v[244:247], v[64:67], v[0:3]
  ds_read_b128 v[40:43], v113 offset:38400
  v_mfma_f32_16x16x32_bf16 v[12:15], v[244:247], v[68:71], v[12:15]
  ds_read_b128 v[44:47], v114 offset:38400
  v_mfma_f32_16x16x32_bf16 v[12:15], v[232:235], v[64:67], v[12:15]
  ds_read_b128 v[48:51], v115 offset:38400
  v_mfma_f32_16x16x32_bf16 v[24:27], v[232:235], v[68:71], v[24:27]
  ds_read_b64_tr_b16 v[208:209], v128 offset:24576
  v_mfma_f32_16x16x32_bf16 v[24:27], v[244:247], v[72:75], v[24:27]
  ds_read_b64_tr_b16 v[210:211], v128 offset:25344
  s_waitcnt lgkmcnt(10)
  v_mfma_f32_16x16x32_bf16 v[28:31], v[248:251], v[72:75], v[28:31]
  ds_read_b64_tr_b16 v[220:221], v128 offset:27648
  v_mfma_f32_16x16x32_bf16 v[28:31], v[236:239], v[68:71], v[28:31]
  ds_read_b64_tr_b16 v[222:223], v128 offset:28416
  v_mfma_f32_16x16x32_bf16 v[16:19], v[236:239], v[64:67], v[16:19]
  ds_read_b64_tr_b16 v[224:225], v128 offset:27680
  v_mfma_f32_16x16x32_bf16 v[16:19], v[248:251], v[68:71], v[16:19]
  ds_read_b64_tr_b16 v[226:227], v128 offset:28448
  v_mfma_f32_16x16x32_bf16 v[4:7], v[248:251], v[64:67], v[4:7]
  ds_read_b64_tr_b16 v[212:213], v128 offset:24608
  v_mfma_f32_16x16x32_bf16 v[4:7], v[236:239], v[60:63], v[4:7]
  ds_read_b64_tr_b16 v[214:215], v128 offset:25376
  s_waitcnt lgkmcnt(12)
  v_mfma_f32_16x16x32_bf16 v[8:11], v[240:243], v[60:63], v[8:11]
  ds_read_b64_tr_b16 v[216:217], v128 offset:24640
  v_mfma_f32_16x16x32_bf16 v[8:11], v[252:255], v[64:67], v[8:11]
  ds_read_b64_tr_b16 v[218:219], v128 offset:25408
  v_mfma_f32_16x16x32_bf16 v[20:23], v[252:255], v[68:71], v[20:23]
  ds_read_b64_tr_b16 v[228:229], v128 offset:27712
  v_mfma_f32_16x16x32_bf16 v[20:23], v[240:243], v[64:67], v[20:23]
  ds_read_b64_tr_b16 v[230:231], v128 offset:28480
  v_mfma_f32_16x16x32_bf16 v[32:35], v[240:243], v[68:71], v[32:35]
  v_mfma_f32_16x16x32_bf16 v[32:35], v[252:255], v[72:75], v[32:35]
  s_waitcnt lgkmcnt(8)
  s_barrier
  v_mfma_f32_16x16x32_bf16 v[0:3], v[208:211], v[36:39], v[0:3]
  ds_read_b128 v[52:55], v116 offset:38400
  v_mfma_f32_16x16x32_bf16 v[0:3], v[220:223], v[40:43], v[0:3]
  ds_read_b128 v[56:59], v117 offset:38400
  v_mfma_f32_16x16x32_bf16 v[12:15], v[220:223], v[44:47], v[12:15]
  ds_read_b64_tr_b16 v[232:233], v128 offset:30720
  v_mfma_f32_16x16x32_bf16 v[12:15], v[208:211], v[40:43], v[12:15]
  ds_read_b64_tr_b16 v[234:235], v128 offset:31488
  v_mfma_f32_16x16x32_bf16 v[24:27], v[208:211], v[44:47], v[24:27]
  ds_read_b64_tr_b16 v[244:245], v128 offset:33792
  v_mfma_f32_16x16x32_bf16 v[24:27], v[220:223], v[48:51], v[24:27]
  ds_read_b64_tr_b16 v[246:247], v128 offset:34560
  s_waitcnt lgkmcnt(10)
  v_mfma_f32_16x16x32_bf16 v[28:31], v[224:227], v[48:51], v[28:31]
  ds_read_b64_tr_b16 v[248:249], v128 offset:33824
  v_mfma_f32_16x16x32_bf16 v[28:31], v[212:215], v[44:47], v[28:31]
  ds_read_b64_tr_b16 v[250:251], v128 offset:34592
  v_mfma_f32_16x16x32_bf16 v[16:19], v[212:215], v[40:43], v[16:19]
  ds_read_b64_tr_b16 v[236:237], v128 offset:30752
  v_mfma_f32_16x16x32_bf16 v[16:19], v[224:227], v[44:47], v[16:19]
  ds_read_b64_tr_b16 v[238:239], v128 offset:31520
  v_mfma_f32_16x16x32_bf16 v[4:7], v[224:227], v[40:43], v[4:7]
  ds_read_b64_tr_b16 v[240:241], v128 offset:30784
  v_mfma_f32_16x16x32_bf16 v[4:7], v[212:215], v[36:39], v[4:7]
  ds_read_b64_tr_b16 v[242:243], v128 offset:31552
  s_waitcnt lgkmcnt(12)
  v_mfma_f32_16x16x32_bf16 v[8:11], v[216:219], v[36:39], v[8:11]
  ds_read_b64_tr_b16 v[252:253], v128 offset:33856
  v_mfma_f32_16x16x32_bf16 v[8:11], v[228:231], v[40:43], v[8:11]
  ds_read_b64_tr_b16 v[254:255], v128 offset:34624
  v_mfma_f32_16x16x32_bf16 v[20:23], v[228:231], v[44:47], v[20:23]
  v_mfma_f32_16x16x32_bf16 v[20:23], v[216:219], v[40:43], v[20:23]
  v_mfma_f32_16x16x32_bf16 v[32:35], v[216:219], v[44:47], v[32:35]
  v_mfma_f32_16x16x32_bf16 v[32:35], v[228:231], v[48:51], v[32:35]
  s_waitcnt lgkmcnt(8)
  s_barrier
  v_mfma_f32_16x16x32_bf16 v[0:3], v[232:235], v[44:47], v[0:3]
  ds_read_b128 v[60:63], v118 offset:38400
  v_mfma_f32_16x16x32_bf16 v[0:3], v[244:247], v[48:51], v[0:3]
  ds_read_b128 v[64:67], v119 offset:38400
  v_mfma_f32_16x16x32_bf16 v[12:15], v[244:247], v[52:55], v[12:15]
  ds_read_b64_tr_b16 v[208:209], v128 offset:36864
  v_mfma_f32_16x16x32_bf16 v[12:15], v[232:235], v[48:51], v[12:15]
  ds_read_b64_tr_b16 v[210:211], v128 offset:37632
  v_mfma_f32_16x16x32_bf16 v[24:27], v[232:235], v[52:55], v[24:27]
  ds_read_b64_tr_b16 v[220:221], v128 offset:39936
  v_mfma_f32_16x16x32_bf16 v[24:27], v[244:247], v[56:59], v[24:27]
  ds_read_b64_tr_b16 v[222:223], v128 offset:40704
  s_waitcnt lgkmcnt(10)
  v_mfma_f32_16x16x32_bf16 v[28:31], v[248:251], v[56:59], v[28:31]
  ds_read_b64_tr_b16 v[224:225], v128 offset:39968
  v_mfma_f32_16x16x32_bf16 v[28:31], v[236:239], v[52:55], v[28:31]
  ds_read_b64_tr_b16 v[226:227], v128 offset:40736
  v_mfma_f32_16x16x32_bf16 v[16:19], v[236:239], v[48:51], v[16:19]
  ds_read_b64_tr_b16 v[212:213], v128 offset:36896
  v_mfma_f32_16x16x32_bf16 v[16:19], v[248:251], v[52:55], v[16:19]
  ds_read_b64_tr_b16 v[214:215], v128 offset:37664
  v_mfma_f32_16x16x32_bf16 v[4:7], v[248:251], v[48:51], v[4:7]
  ds_read_b64_tr_b16 v[216:217], v128 offset:36928
  v_mfma_f32_16x16x32_bf16 v[4:7], v[236:239], v[44:47], v[4:7]
  ds_read_b64_tr_b16 v[218:219], v128 offset:37696
  s_waitcnt lgkmcnt(12)
  v_mfma_f32_16x16x32_bf16 v[8:11], v[240:243], v[44:47], v[8:11]
  ds_read_b64_tr_b16 v[228:229], v128 offset:40000
  v_mfma_f32_16x16x32_bf16 v[8:11], v[252:255], v[48:51], v[8:11]
  ds_read_b64_tr_b16 v[230:231], v128 offset:40768
  v_mfma_f32_16x16x32_bf16 v[20:23], v[252:255], v[52:55], v[20:23]
  v_mfma_f32_16x16x32_bf16 v[20:23], v[240:243], v[48:51], v[20:23]
  v_mfma_f32_16x16x32_bf16 v[32:35], v[240:243], v[52:55], v[32:35]
  v_mfma_f32_16x16x32_bf16 v[32:35], v[252:255], v[56:59], v[32:35]
  s_waitcnt lgkmcnt(8)
  s_barrier
  v_mfma_f32_16x16x32_bf16 v[0:3], v[208:211], v[52:55], v[0:3]
  ds_read_b128 v[68:71], v112 offset:38912
  v_mfma_f32_16x16x32_bf16 v[0:3], v[220:223], v[56:59], v[0:3]
  ds_read_b128 v[36:39], v112 offset:12800
  v_mfma_f32_16x16x32_bf16 v[12:15], v[220:223], v[60:63], v[12:15]
  ds_read_b128 v[40:43], v113 offset:12800
  v_mfma_f32_16x16x32_bf16 v[12:15], v[208:211], v[56:59], v[12:15]
  ds_read_b128 v[44:47], v114 offset:12800
  v_mfma_f32_16x16x32_bf16 v[24:27], v[208:211], v[60:63], v[24:27]
  ds_read_b64_tr_b16 v[232:233], v128 offset:43008
  v_mfma_f32_16x16x32_bf16 v[24:27], v[220:223], v[64:67], v[24:27]
  ds_read_b64_tr_b16 v[234:235], v128 offset:43776
  s_waitcnt lgkmcnt(10)
  v_mfma_f32_16x16x32_bf16 v[28:31], v[224:227], v[64:67], v[28:31]
  ds_read_b64_tr_b16 v[244:245], v128 offset:0
  v_mfma_f32_16x16x32_bf16 v[28:31], v[212:215], v[60:63], v[28:31]
  ds_read_b64_tr_b16 v[246:247], v128 offset:768
  v_mfma_f32_16x16x32_bf16 v[16:19], v[212:215], v[56:59], v[16:19]
  ds_read_b64_tr_b16 v[248:249], v128 offset:32
  v_mfma_f32_16x16x32_bf16 v[16:19], v[224:227], v[60:63], v[16:19]
  ds_read_b64_tr_b16 v[250:251], v128 offset:800
  v_mfma_f32_16x16x32_bf16 v[4:7], v[224:227], v[56:59], v[4:7]
  ds_read_b64_tr_b16 v[236:237], v128 offset:43040
  v_mfma_f32_16x16x32_bf16 v[4:7], v[212:215], v[52:55], v[4:7]
  ds_read_b64_tr_b16 v[238:239], v128 offset:43808
  s_waitcnt lgkmcnt(12)
  v_mfma_f32_16x16x32_bf16 v[8:11], v[216:219], v[52:55], v[8:11]
  ds_read_b64_tr_b16 v[240:241], v128 offset:43072
  v_mfma_f32_16x16x32_bf16 v[8:11], v[228:231], v[56:59], v[8:11]
  ds_read_b64_tr_b16 v[242:243], v128 offset:43840
  v_mfma_f32_16x16x32_bf16 v[20:23], v[228:231], v[60:63], v[20:23]
  ds_read_b64_tr_b16 v[252:253], v128 offset:64
  v_mfma_f32_16x16x32_bf16 v[20:23], v[216:219], v[56:59], v[20:23]
  ds_read_b64_tr_b16 v[254:255], v128 offset:832
  v_mfma_f32_16x16x32_bf16 v[32:35], v[216:219], v[60:63], v[32:35]
  v_mfma_f32_16x16x32_bf16 v[32:35], v[228:231], v[64:67], v[32:35]
  s_waitcnt lgkmcnt(8)
  s_barrier
  v_mfma_f32_16x16x32_bf16 v[0:3], v[232:235], v[60:63], v[0:3]
  ds_read_b128 v[48:51], v115 offset:12800
  v_mfma_f32_16x16x32_bf16 v[0:3], v[244:247], v[36:39], v[0:3]
  ds_read_b128 v[52:55], v116 offset:12800
  v_mfma_f32_16x16x32_bf16 v[12:15], v[244:247], v[40:43], v[12:15]
  ds_read_b64_tr_b16 v[208:209], v128 offset:3072
  v_mfma_f32_16x16x32_bf16 v[12:15], v[232:235], v[64:67], v[12:15]
  ds_read_b64_tr_b16 v[210:211], v128 offset:3840
  v_mfma_f32_16x16x32_bf16 v[24:27], v[232:235], v[68:71], v[24:27]
  ds_read_b64_tr_b16 v[220:221], v128 offset:6144
  v_mfma_f32_16x16x32_bf16 v[24:27], v[244:247], v[44:47], v[24:27]
  ds_read_b64_tr_b16 v[222:223], v128 offset:6912
  s_waitcnt lgkmcnt(10)
  v_mfma_f32_16x16x32_bf16 v[28:31], v[248:251], v[44:47], v[28:31]
  ds_read_b64_tr_b16 v[224:225], v128 offset:6176
  v_mfma_f32_16x16x32_bf16 v[28:31], v[236:239], v[68:71], v[28:31]
  ds_read_b64_tr_b16 v[226:227], v128 offset:6944
  v_mfma_f32_16x16x32_bf16 v[16:19], v[236:239], v[64:67], v[16:19]
  ds_read_b64_tr_b16 v[212:213], v128 offset:3104
  v_mfma_f32_16x16x32_bf16 v[16:19], v[248:251], v[40:43], v[16:19]
  ds_read_b64_tr_b16 v[214:215], v128 offset:3872
  v_mfma_f32_16x16x32_bf16 v[4:7], v[248:251], v[36:39], v[4:7]
  ds_read_b64_tr_b16 v[216:217], v128 offset:3136
  v_mfma_f32_16x16x32_bf16 v[4:7], v[236:239], v[60:63], v[4:7]
  ds_read_b64_tr_b16 v[218:219], v128 offset:3904
  s_waitcnt lgkmcnt(12)
  v_mfma_f32_16x16x32_bf16 v[8:11], v[240:243], v[60:63], v[8:11]
  ds_read_b64_tr_b16 v[228:229], v128 offset:6208
  v_mfma_f32_16x16x32_bf16 v[8:11], v[252:255], v[36:39], v[8:11]
  ds_read_b64_tr_b16 v[230:231], v128 offset:6976
  v_mfma_f32_16x16x32_bf16 v[20:23], v[252:255], v[40:43], v[20:23]
  v_mfma_f32_16x16x32_bf16 v[20:23], v[240:243], v[64:67], v[20:23]
  v_mfma_f32_16x16x32_bf16 v[32:35], v[240:243], v[68:71], v[32:35]
  v_mfma_f32_16x16x32_bf16 v[32:35], v[252:255], v[44:47], v[32:35]
  s_waitcnt lgkmcnt(8)
  s_barrier
  v_mfma_f32_16x16x32_bf16 v[0:3], v[208:211], v[40:43], v[0:3]
  ds_read_b128 v[56:59], v117 offset:12800
  v_mfma_f32_16x16x32_bf16 v[0:3], v[220:223], v[44:47], v[0:3]
  ds_read_b128 v[60:63], v118 offset:12800
  v_mfma_f32_16x16x32_bf16 v[12:15], v[220:223], v[48:51], v[12:15]
  ds_read_b64_tr_b16 v[232:233], v128 offset:9216
  v_mfma_f32_16x16x32_bf16 v[12:15], v[208:211], v[44:47], v[12:15]
  ds_read_b64_tr_b16 v[234:235], v128 offset:9984
  v_mfma_f32_16x16x32_bf16 v[24:27], v[208:211], v[48:51], v[24:27]
  ds_read_b64_tr_b16 v[244:245], v128 offset:12288
  v_mfma_f32_16x16x32_bf16 v[24:27], v[220:223], v[52:55], v[24:27]
  ds_read_b64_tr_b16 v[246:247], v128 offset:13056
  s_waitcnt lgkmcnt(10)
  v_mfma_f32_16x16x32_bf16 v[28:31], v[224:227], v[52:55], v[28:31]
  ds_read_b64_tr_b16 v[248:249], v128 offset:12320
  v_mfma_f32_16x16x32_bf16 v[28:31], v[212:215], v[48:51], v[28:31]
  ds_read_b64_tr_b16 v[250:251], v128 offset:13088
  v_mfma_f32_16x16x32_bf16 v[16:19], v[212:215], v[44:47], v[16:19]
  ds_read_b64_tr_b16 v[236:237], v128 offset:9248
  v_mfma_f32_16x16x32_bf16 v[16:19], v[224:227], v[48:51], v[16:19]
  ds_read_b64_tr_b16 v[238:239], v128 offset:10016
  v_mfma_f32_16x16x32_bf16 v[4:7], v[224:227], v[44:47], v[4:7]
  ds_read_b64_tr_b16 v[240:241], v128 offset:9280
  v_mfma_f32_16x16x32_bf16 v[4:7], v[212:215], v[40:43], v[4:7]
  ds_read_b64_tr_b16 v[242:243], v128 offset:10048
  s_waitcnt lgkmcnt(12)
  v_mfma_f32_16x16x32_bf16 v[8:11], v[216:219], v[40:43], v[8:11]
  ds_read_b64_tr_b16 v[252:253], v128 offset:12352
  v_mfma_f32_16x16x32_bf16 v[8:11], v[228:231], v[44:47], v[8:11]
  ds_read_b64_tr_b16 v[254:255], v128 offset:13120
  v_mfma_f32_16x16x32_bf16 v[20:23], v[228:231], v[48:51], v[20:23]
  v_mfma_f32_16x16x32_bf16 v[20:23], v[216:219], v[44:47], v[20:23]
  v_mfma_f32_16x16x32_bf16 v[32:35], v[216:219], v[48:51], v[32:35]
  v_mfma_f32_16x16x32_bf16 v[32:35], v[228:231], v[52:55], v[32:35]
  s_waitcnt lgkmcnt(8)
  s_barrier
  v_mfma_f32_16x16x32_bf16 v[0:3], v[232:235], v[48:51], v[0:3]
  ds_read_b128 v[64:67], v119 offset:12800
  v_mfma_f32_16x16x32_bf16 v[0:3], v[244:247], v[52:55], v[0:3]
  ds_read_b128 v[68:71], v112 offset:13312
  v_mfma_f32_16x16x32_bf16 v[12:15], v[244:247], v[56:59], v[12:15]
  ds_read_b64_tr_b16 v[208:209], v128 offset:15360
  v_mfma_f32_16x16x32_bf16 v[12:15], v[232:235], v[52:55], v[12:15]
  ds_read_b64_tr_b16 v[210:211], v128 offset:16128
  v_mfma_f32_16x16x32_bf16 v[24:27], v[232:235], v[56:59], v[24:27]
  ds_read_b64_tr_b16 v[220:221], v128 offset:18432
  v_mfma_f32_16x16x32_bf16 v[24:27], v[244:247], v[60:63], v[24:27]
  ds_read_b64_tr_b16 v[222:223], v128 offset:19200
  s_waitcnt lgkmcnt(10)
  v_mfma_f32_16x16x32_bf16 v[28:31], v[248:251], v[60:63], v[28:31]
  ds_read_b64_tr_b16 v[224:225], v128 offset:18464
  v_mfma_f32_16x16x32_bf16 v[28:31], v[236:239], v[56:59], v[28:31]
  ds_read_b64_tr_b16 v[226:227], v128 offset:19232
  v_mfma_f32_16x16x32_bf16 v[16:19], v[236:239], v[52:55], v[16:19]
  ds_read_b64_tr_b16 v[212:213], v128 offset:15392
  v_mfma_f32_16x16x32_bf16 v[16:19], v[248:251], v[56:59], v[16:19]
  ds_read_b64_tr_b16 v[214:215], v128 offset:16160
  v_mfma_f32_16x16x32_bf16 v[4:7], v[248:251], v[52:55], v[4:7]
  ds_read_b64_tr_b16 v[216:217], v128 offset:15424
  v_mfma_f32_16x16x32_bf16 v[4:7], v[236:239], v[48:51], v[4:7]
  ds_read_b64_tr_b16 v[218:219], v128 offset:16192
  s_waitcnt lgkmcnt(12)
  v_mfma_f32_16x16x32_bf16 v[8:11], v[240:243], v[48:51], v[8:11]
  ds_read_b64_tr_b16 v[228:229], v128 offset:18496
  v_mfma_f32_16x16x32_bf16 v[8:11], v[252:255], v[52:55], v[8:11]
  ds_read_b64_tr_b16 v[230:231], v128 offset:19264
  v_mfma_f32_16x16x32_bf16 v[20:23], v[252:255], v[56:59], v[20:23]
  v_mfma_f32_16x16x32_bf16 v[20:23], v[240:243], v[52:55], v[20:23]
  v_mfma_f32_16x16x32_bf16 v[32:35], v[240:243], v[56:59], v[32:35]
  v_mfma_f32_16x16x32_bf16 v[32:35], v[252:255], v[60:63], v[32:35]
  s_waitcnt lgkmcnt(8)
  s_barrier
  v_mfma_f32_16x16x32_bf16 v[0:3], v[208:211], v[56:59], v[0:3]
  ds_read_b128 v[72:75], v113 offset:13312
  v_mfma_f32_16x16x32_bf16 v[0:3], v[220:223], v[60:63], v[0:3]
  ds_read_b128 v[36:39], v120 offset:38400
  v_mfma_f32_16x16x32_bf16 v[12:15], v[220:223], v[64:67], v[12:15]
  ds_read_b128 v[40:43], v121 offset:38400
  v_mfma_f32_16x16x32_bf16 v[12:15], v[208:211], v[60:63], v[12:15]
  ds_read_b128 v[44:47], v122 offset:38400
  v_mfma_f32_16x16x32_bf16 v[24:27], v[208:211], v[64:67], v[24:27]
  ds_read_b64_tr_b16 v[232:233], v128 offset:21504
  v_mfma_f32_16x16x32_bf16 v[24:27], v[220:223], v[68:71], v[24:27]
  ds_read_b64_tr_b16 v[234:235], v128 offset:22272
  s_waitcnt lgkmcnt(10)
  v_mfma_f32_16x16x32_bf16 v[28:31], v[224:227], v[68:71], v[28:31]
  ds_read_b64_tr_b16 v[244:245], v128 offset:24576
  v_mfma_f32_16x16x32_bf16 v[28:31], v[212:215], v[64:67], v[28:31]
  ds_read_b64_tr_b16 v[246:247], v128 offset:25344
  v_mfma_f32_16x16x32_bf16 v[16:19], v[212:215], v[60:63], v[16:19]
  ds_read_b64_tr_b16 v[248:249], v128 offset:24608
  v_mfma_f32_16x16x32_bf16 v[16:19], v[224:227], v[64:67], v[16:19]
  ds_read_b64_tr_b16 v[250:251], v128 offset:25376
  v_mfma_f32_16x16x32_bf16 v[4:7], v[224:227], v[60:63], v[4:7]
  ds_read_b64_tr_b16 v[236:237], v128 offset:21536
  v_mfma_f32_16x16x32_bf16 v[4:7], v[212:215], v[56:59], v[4:7]
  ds_read_b64_tr_b16 v[238:239], v128 offset:22304
  s_waitcnt lgkmcnt(12)
  v_mfma_f32_16x16x32_bf16 v[8:11], v[216:219], v[56:59], v[8:11]
  ds_read_b64_tr_b16 v[240:241], v128 offset:21568
  v_mfma_f32_16x16x32_bf16 v[8:11], v[228:231], v[60:63], v[8:11]
  ds_read_b64_tr_b16 v[242:243], v128 offset:22336
  v_mfma_f32_16x16x32_bf16 v[20:23], v[228:231], v[64:67], v[20:23]
  ds_read_b64_tr_b16 v[252:253], v128 offset:24640
  v_mfma_f32_16x16x32_bf16 v[20:23], v[216:219], v[60:63], v[20:23]
  ds_read_b64_tr_b16 v[254:255], v128 offset:25408
  v_mfma_f32_16x16x32_bf16 v[32:35], v[216:219], v[64:67], v[32:35]
  v_mfma_f32_16x16x32_bf16 v[32:35], v[228:231], v[68:71], v[32:35]
  s_waitcnt lgkmcnt(8)
  s_barrier
  v_mfma_f32_16x16x32_bf16 v[0:3], v[232:235], v[64:67], v[0:3]
  ds_read_b128 v[48:51], v123 offset:38400
  v_mfma_f32_16x16x32_bf16 v[0:3], v[244:247], v[36:39], v[0:3]
  ds_read_b128 v[52:55], v124 offset:38400
  v_mfma_f32_16x16x32_bf16 v[12:15], v[244:247], v[40:43], v[12:15]
  ds_read_b64_tr_b16 v[208:209], v128 offset:27648
  v_mfma_f32_16x16x32_bf16 v[12:15], v[232:235], v[68:71], v[12:15]
  ds_read_b64_tr_b16 v[210:211], v128 offset:28416
  v_mfma_f32_16x16x32_bf16 v[24:27], v[232:235], v[72:75], v[24:27]
  ds_read_b64_tr_b16 v[220:221], v128 offset:30720
  v_mfma_f32_16x16x32_bf16 v[24:27], v[244:247], v[44:47], v[24:27]
  ds_read_b64_tr_b16 v[222:223], v128 offset:31488
  s_waitcnt lgkmcnt(10)
  v_mfma_f32_16x16x32_bf16 v[28:31], v[248:251], v[44:47], v[28:31]
  ds_read_b64_tr_b16 v[224:225], v128 offset:30752
  v_mfma_f32_16x16x32_bf16 v[28:31], v[236:239], v[72:75], v[28:31]
  ds_read_b64_tr_b16 v[226:227], v128 offset:31520
  v_mfma_f32_16x16x32_bf16 v[16:19], v[236:239], v[68:71], v[16:19]
  ds_read_b64_tr_b16 v[212:213], v128 offset:27680
  v_mfma_f32_16x16x32_bf16 v[16:19], v[248:251], v[40:43], v[16:19]
  ds_read_b64_tr_b16 v[214:215], v128 offset:28448
  v_mfma_f32_16x16x32_bf16 v[4:7], v[248:251], v[36:39], v[4:7]
  ds_read_b64_tr_b16 v[216:217], v128 offset:27712
  v_mfma_f32_16x16x32_bf16 v[4:7], v[236:239], v[64:67], v[4:7]
  ds_read_b64_tr_b16 v[218:219], v128 offset:28480
  s_waitcnt lgkmcnt(12)
  v_mfma_f32_16x16x32_bf16 v[8:11], v[240:243], v[64:67], v[8:11]
  ds_read_b64_tr_b16 v[228:229], v128 offset:30784
  v_mfma_f32_16x16x32_bf16 v[8:11], v[252:255], v[36:39], v[8:11]
  ds_read_b64_tr_b16 v[230:231], v128 offset:31552
  v_mfma_f32_16x16x32_bf16 v[20:23], v[252:255], v[40:43], v[20:23]
  v_mfma_f32_16x16x32_bf16 v[20:23], v[240:243], v[68:71], v[20:23]
  v_mfma_f32_16x16x32_bf16 v[32:35], v[240:243], v[72:75], v[32:35]
  v_mfma_f32_16x16x32_bf16 v[32:35], v[252:255], v[44:47], v[32:35]
  s_waitcnt lgkmcnt(8)
  s_barrier
  v_mfma_f32_16x16x32_bf16 v[0:3], v[208:211], v[40:43], v[0:3]
  ds_read_b128 v[56:59], v125 offset:38400
  v_mfma_f32_16x16x32_bf16 v[0:3], v[220:223], v[44:47], v[0:3]
  ds_read_b128 v[60:63], v126 offset:38400
  v_mfma_f32_16x16x32_bf16 v[12:15], v[220:223], v[48:51], v[12:15]
  ds_read_b64_tr_b16 v[232:233], v128 offset:33792
  v_mfma_f32_16x16x32_bf16 v[12:15], v[208:211], v[44:47], v[12:15]
  ds_read_b64_tr_b16 v[234:235], v128 offset:34560
  v_mfma_f32_16x16x32_bf16 v[24:27], v[208:211], v[48:51], v[24:27]
  ds_read_b64_tr_b16 v[244:245], v128 offset:36864
  v_mfma_f32_16x16x32_bf16 v[24:27], v[220:223], v[52:55], v[24:27]
  ds_read_b64_tr_b16 v[246:247], v128 offset:37632
  s_waitcnt lgkmcnt(10)
  v_mfma_f32_16x16x32_bf16 v[28:31], v[224:227], v[52:55], v[28:31]
  ds_read_b64_tr_b16 v[248:249], v128 offset:36896
  v_mfma_f32_16x16x32_bf16 v[28:31], v[212:215], v[48:51], v[28:31]
  ds_read_b64_tr_b16 v[250:251], v128 offset:37664
  v_mfma_f32_16x16x32_bf16 v[16:19], v[212:215], v[44:47], v[16:19]
  ds_read_b64_tr_b16 v[236:237], v128 offset:33824
  v_mfma_f32_16x16x32_bf16 v[16:19], v[224:227], v[48:51], v[16:19]
  ds_read_b64_tr_b16 v[238:239], v128 offset:34592
  v_mfma_f32_16x16x32_bf16 v[4:7], v[224:227], v[44:47], v[4:7]
  ds_read_b64_tr_b16 v[240:241], v128 offset:33856
  v_mfma_f32_16x16x32_bf16 v[4:7], v[212:215], v[40:43], v[4:7]
  ds_read_b64_tr_b16 v[242:243], v128 offset:34624
  s_waitcnt lgkmcnt(12)
  v_mfma_f32_16x16x32_bf16 v[8:11], v[216:219], v[40:43], v[8:11]
  ds_read_b64_tr_b16 v[252:253], v128 offset:36928
  v_mfma_f32_16x16x32_bf16 v[8:11], v[228:231], v[44:47], v[8:11]
  ds_read_b64_tr_b16 v[254:255], v128 offset:37696
  v_mfma_f32_16x16x32_bf16 v[20:23], v[228:231], v[48:51], v[20:23]
  v_mfma_f32_16x16x32_bf16 v[20:23], v[216:219], v[44:47], v[20:23]
  v_mfma_f32_16x16x32_bf16 v[32:35], v[216:219], v[48:51], v[32:35]
  v_mfma_f32_16x16x32_bf16 v[32:35], v[228:231], v[52:55], v[32:35]
  s_waitcnt lgkmcnt(8)
  s_barrier
  v_mfma_f32_16x16x32_bf16 v[0:3], v[232:235], v[48:51], v[0:3]
  ds_read_b128 v[64:67], v127 offset:38400
  v_mfma_f32_16x16x32_bf16 v[0:3], v[244:247], v[52:55], v[0:3]
  ds_read_b128 v[68:71], v120 offset:38912
  v_mfma_f32_16x16x32_bf16 v[12:15], v[244:247], v[56:59], v[12:15]
  ds_read_b64_tr_b16 v[208:209], v128 offset:39936
  v_mfma_f32_16x16x32_bf16 v[12:15], v[232:235], v[52:55], v[12:15]
  ds_read_b64_tr_b16 v[210:211], v128 offset:40704
  v_mfma_f32_16x16x32_bf16 v[24:27], v[232:235], v[56:59], v[24:27]
  ds_read_b64_tr_b16 v[220:221], v128 offset:43008
  v_mfma_f32_16x16x32_bf16 v[24:27], v[244:247], v[60:63], v[24:27]
  ds_read_b64_tr_b16 v[222:223], v128 offset:43776
  s_waitcnt lgkmcnt(10)
  v_mfma_f32_16x16x32_bf16 v[28:31], v[248:251], v[60:63], v[28:31]
  ds_read_b64_tr_b16 v[224:225], v128 offset:43040
  v_mfma_f32_16x16x32_bf16 v[28:31], v[236:239], v[56:59], v[28:31]
  ds_read_b64_tr_b16 v[226:227], v128 offset:43808
  v_mfma_f32_16x16x32_bf16 v[16:19], v[236:239], v[52:55], v[16:19]
  ds_read_b64_tr_b16 v[212:213], v128 offset:39968
  v_mfma_f32_16x16x32_bf16 v[16:19], v[248:251], v[56:59], v[16:19]
  ds_read_b64_tr_b16 v[214:215], v128 offset:40736
  v_mfma_f32_16x16x32_bf16 v[4:7], v[248:251], v[52:55], v[4:7]
  ds_read_b64_tr_b16 v[216:217], v128 offset:40000
  v_mfma_f32_16x16x32_bf16 v[4:7], v[236:239], v[48:51], v[4:7]
  ds_read_b64_tr_b16 v[218:219], v128 offset:40768
  s_waitcnt lgkmcnt(12)
  v_mfma_f32_16x16x32_bf16 v[8:11], v[240:243], v[48:51], v[8:11]
  ds_read_b64_tr_b16 v[228:229], v128 offset:43072
  v_mfma_f32_16x16x32_bf16 v[8:11], v[252:255], v[52:55], v[8:11]
  ds_read_b64_tr_b16 v[230:231], v128 offset:43840
  v_mfma_f32_16x16x32_bf16 v[20:23], v[252:255], v[56:59], v[20:23]
  v_mfma_f32_16x16x32_bf16 v[20:23], v[240:243], v[52:55], v[20:23]
  v_mfma_f32_16x16x32_bf16 v[32:35], v[240:243], v[56:59], v[32:35]
  v_mfma_f32_16x16x32_bf16 v[32:35], v[252:255], v[60:63], v[32:35]
  s_waitcnt lgkmcnt(8)
  s_barrier
  v_mfma_f32_16x16x32_bf16 v[0:3], v[208:211], v[56:59], v[0:3]
  ds_read_b128 v[36:39], v120 offset:0
  v_mfma_f32_16x16x32_bf16 v[0:3], v[220:223], v[60:63], v[0:3]
  ds_read_b128 v[40:43], v121 offset:0
  v_mfma_f32_16x16x32_bf16 v[12:15], v[220:223], v[64:67], v[12:15]
  ds_read_b128 v[44:47], v122 offset:0
  v_mfma_f32_16x16x32_bf16 v[12:15], v[208:211], v[60:63], v[12:15]
  ds_read_b128 v[48:51], v123 offset:0
  v_mfma_f32_16x16x32_bf16 v[24:27], v[208:211], v[64:67], v[24:27]
  ds_read_b64_tr_b16 v[232:233], v128 offset:0
  v_mfma_f32_16x16x32_bf16 v[24:27], v[220:223], v[68:71], v[24:27]
  ds_read_b64_tr_b16 v[234:235], v128 offset:768
  s_waitcnt lgkmcnt(10)
  v_mfma_f32_16x16x32_bf16 v[28:31], v[224:227], v[68:71], v[28:31]
  ds_read_b64_tr_b16 v[244:245], v128 offset:3072
  v_mfma_f32_16x16x32_bf16 v[28:31], v[212:215], v[64:67], v[28:31]
  ds_read_b64_tr_b16 v[246:247], v128 offset:3840
  v_mfma_f32_16x16x32_bf16 v[16:19], v[212:215], v[60:63], v[16:19]
  ds_read_b64_tr_b16 v[248:249], v128 offset:3104
  v_mfma_f32_16x16x32_bf16 v[16:19], v[224:227], v[64:67], v[16:19]
  ds_read_b64_tr_b16 v[250:251], v128 offset:3872
  v_mfma_f32_16x16x32_bf16 v[4:7], v[224:227], v[60:63], v[4:7]
  ds_read_b64_tr_b16 v[236:237], v128 offset:32
  v_mfma_f32_16x16x32_bf16 v[4:7], v[212:215], v[56:59], v[4:7]
  ds_read_b64_tr_b16 v[238:239], v128 offset:800
  s_waitcnt lgkmcnt(12)
  v_mfma_f32_16x16x32_bf16 v[8:11], v[216:219], v[56:59], v[8:11]
  ds_read_b64_tr_b16 v[240:241], v128 offset:64
  v_mfma_f32_16x16x32_bf16 v[8:11], v[228:231], v[60:63], v[8:11]
  ds_read_b64_tr_b16 v[242:243], v128 offset:832
  v_mfma_f32_16x16x32_bf16 v[20:23], v[228:231], v[64:67], v[20:23]
  ds_read_b64_tr_b16 v[252:253], v128 offset:3136
  v_mfma_f32_16x16x32_bf16 v[20:23], v[216:219], v[60:63], v[20:23]
  ds_read_b64_tr_b16 v[254:255], v128 offset:3904
  v_mfma_f32_16x16x32_bf16 v[32:35], v[216:219], v[64:67], v[32:35]
  v_mfma_f32_16x16x32_bf16 v[32:35], v[228:231], v[68:71], v[32:35]
  s_waitcnt lgkmcnt(8)
  s_barrier
  v_mfma_f32_16x16x32_bf16 v[0:3], v[232:235], v[36:39], v[0:3]
  ds_read_b128 v[52:55], v124 offset:0
  v_mfma_f32_16x16x32_bf16 v[0:3], v[244:247], v[40:43], v[0:3]
  ds_read_b128 v[56:59], v125 offset:0
  v_mfma_f32_16x16x32_bf16 v[12:15], v[244:247], v[44:47], v[12:15]
  ds_read_b64_tr_b16 v[208:209], v128 offset:6144
  v_mfma_f32_16x16x32_bf16 v[12:15], v[232:235], v[40:43], v[12:15]
  ds_read_b64_tr_b16 v[210:211], v128 offset:6912
  v_mfma_f32_16x16x32_bf16 v[24:27], v[232:235], v[44:47], v[24:27]
  ds_read_b64_tr_b16 v[220:221], v128 offset:9216
  v_mfma_f32_16x16x32_bf16 v[24:27], v[244:247], v[48:51], v[24:27]
  ds_read_b64_tr_b16 v[222:223], v128 offset:9984
  s_waitcnt lgkmcnt(10)
  v_mfma_f32_16x16x32_bf16 v[28:31], v[248:251], v[48:51], v[28:31]
  ds_read_b64_tr_b16 v[224:225], v128 offset:9248
  v_mfma_f32_16x16x32_bf16 v[28:31], v[236:239], v[44:47], v[28:31]
  ds_read_b64_tr_b16 v[226:227], v128 offset:10016
  v_mfma_f32_16x16x32_bf16 v[16:19], v[236:239], v[40:43], v[16:19]
  ds_read_b64_tr_b16 v[212:213], v128 offset:6176
  v_mfma_f32_16x16x32_bf16 v[16:19], v[248:251], v[44:47], v[16:19]
  ds_read_b64_tr_b16 v[214:215], v128 offset:6944
  v_mfma_f32_16x16x32_bf16 v[4:7], v[248:251], v[40:43], v[4:7]
  ds_read_b64_tr_b16 v[216:217], v128 offset:6208
  v_mfma_f32_16x16x32_bf16 v[4:7], v[236:239], v[36:39], v[4:7]
  ds_read_b64_tr_b16 v[218:219], v128 offset:6976
  s_waitcnt lgkmcnt(12)
  v_mfma_f32_16x16x32_bf16 v[8:11], v[240:243], v[36:39], v[8:11]
  ds_read_b64_tr_b16 v[228:229], v128 offset:9280
  v_mfma_f32_16x16x32_bf16 v[8:11], v[252:255], v[40:43], v[8:11]
  ds_read_b64_tr_b16 v[230:231], v128 offset:10048
  v_mfma_f32_16x16x32_bf16 v[20:23], v[252:255], v[44:47], v[20:23]
  v_mfma_f32_16x16x32_bf16 v[20:23], v[240:243], v[40:43], v[20:23]
  v_mfma_f32_16x16x32_bf16 v[32:35], v[240:243], v[44:47], v[32:35]
  v_mfma_f32_16x16x32_bf16 v[32:35], v[252:255], v[48:51], v[32:35]
  s_waitcnt lgkmcnt(8)
  s_barrier
  v_mfma_f32_16x16x32_bf16 v[0:3], v[208:211], v[44:47], v[0:3]
  ds_read_b128 v[60:63], v126 offset:0
  v_mfma_f32_16x16x32_bf16 v[0:3], v[220:223], v[48:51], v[0:3]
  ds_read_b128 v[64:67], v127 offset:0
  v_mfma_f32_16x16x32_bf16 v[12:15], v[220:223], v[52:55], v[12:15]
  ds_read_b64_tr_b16 v[232:233], v128 offset:12288
  v_mfma_f32_16x16x32_bf16 v[12:15], v[208:211], v[48:51], v[12:15]
  ds_read_b64_tr_b16 v[234:235], v128 offset:13056
  v_mfma_f32_16x16x32_bf16 v[24:27], v[208:211], v[52:55], v[24:27]
  ds_read_b64_tr_b16 v[244:245], v128 offset:15360
  v_mfma_f32_16x16x32_bf16 v[24:27], v[220:223], v[56:59], v[24:27]
  ds_read_b64_tr_b16 v[246:247], v128 offset:16128
  s_waitcnt lgkmcnt(10)
  v_mfma_f32_16x16x32_bf16 v[28:31], v[224:227], v[56:59], v[28:31]
  ds_read_b64_tr_b16 v[248:249], v128 offset:15392
  v_mfma_f32_16x16x32_bf16 v[28:31], v[212:215], v[52:55], v[28:31]
  ds_read_b64_tr_b16 v[250:251], v128 offset:16160
  v_mfma_f32_16x16x32_bf16 v[16:19], v[212:215], v[48:51], v[16:19]
  ds_read_b64_tr_b16 v[236:237], v128 offset:12320
  v_mfma_f32_16x16x32_bf16 v[16:19], v[224:227], v[52:55], v[16:19]
  ds_read_b64_tr_b16 v[238:239], v128 offset:13088
  v_mfma_f32_16x16x32_bf16 v[4:7], v[224:227], v[48:51], v[4:7]
  ds_read_b64_tr_b16 v[240:241], v128 offset:12352
  v_mfma_f32_16x16x32_bf16 v[4:7], v[212:215], v[44:47], v[4:7]
  ds_read_b64_tr_b16 v[242:243], v128 offset:13120
  s_waitcnt lgkmcnt(12)
  v_mfma_f32_16x16x32_bf16 v[8:11], v[216:219], v[44:47], v[8:11]
  ds_read_b64_tr_b16 v[252:253], v128 offset:15424
  v_mfma_f32_16x16x32_bf16 v[8:11], v[228:231], v[48:51], v[8:11]
  ds_read_b64_tr_b16 v[254:255], v128 offset:16192
  v_mfma_f32_16x16x32_bf16 v[20:23], v[228:231], v[52:55], v[20:23]
  v_mfma_f32_16x16x32_bf16 v[20:23], v[216:219], v[48:51], v[20:23]
  v_mfma_f32_16x16x32_bf16 v[32:35], v[216:219], v[52:55], v[32:35]
  v_mfma_f32_16x16x32_bf16 v[32:35], v[228:231], v[56:59], v[32:35]
  s_waitcnt lgkmcnt(8)
  s_barrier
  v_mfma_f32_16x16x32_bf16 v[0:3], v[232:235], v[52:55], v[0:3]
  ds_read_b128 v[68:71], v120 offset:512
  v_mfma_f32_16x16x32_bf16 v[0:3], v[244:247], v[56:59], v[0:3]
  ds_read_b128 v[72:75], v121 offset:512
  v_mfma_f32_16x16x32_bf16 v[12:15], v[244:247], v[60:63], v[12:15]
  ds_read_b64_tr_b16 v[208:209], v128 offset:18432
  v_mfma_f32_16x16x32_bf16 v[12:15], v[232:235], v[56:59], v[12:15]
  ds_read_b64_tr_b16 v[210:211], v128 offset:19200
  v_mfma_f32_16x16x32_bf16 v[24:27], v[232:235], v[60:63], v[24:27]
  ds_read_b64_tr_b16 v[220:221], v128 offset:21504
  v_mfma_f32_16x16x32_bf16 v[24:27], v[244:247], v[64:67], v[24:27]
  ds_read_b64_tr_b16 v[222:223], v128 offset:22272
  s_waitcnt lgkmcnt(10)
  v_mfma_f32_16x16x32_bf16 v[28:31], v[248:251], v[64:67], v[28:31]
  ds_read_b64_tr_b16 v[224:225], v128 offset:21536
  v_mfma_f32_16x16x32_bf16 v[28:31], v[236:239], v[60:63], v[28:31]
  ds_read_b64_tr_b16 v[226:227], v128 offset:22304
  v_mfma_f32_16x16x32_bf16 v[16:19], v[236:239], v[56:59], v[16:19]
  ds_read_b64_tr_b16 v[212:213], v128 offset:18464
  v_mfma_f32_16x16x32_bf16 v[16:19], v[248:251], v[60:63], v[16:19]
  ds_read_b64_tr_b16 v[214:215], v128 offset:19232
  v_mfma_f32_16x16x32_bf16 v[4:7], v[248:251], v[56:59], v[4:7]
  ds_read_b64_tr_b16 v[216:217], v128 offset:18496
  v_mfma_f32_16x16x32_bf16 v[4:7], v[236:239], v[52:55], v[4:7]
  ds_read_b64_tr_b16 v[218:219], v128 offset:19264
  s_waitcnt lgkmcnt(12)
  v_mfma_f32_16x16x32_bf16 v[8:11], v[240:243], v[52:55], v[8:11]
  ds_read_b64_tr_b16 v[228:229], v128 offset:21568
  v_mfma_f32_16x16x32_bf16 v[8:11], v[252:255], v[56:59], v[8:11]
  ds_read_b64_tr_b16 v[230:231], v128 offset:22336
  v_mfma_f32_16x16x32_bf16 v[20:23], v[252:255], v[60:63], v[20:23]
  v_mfma_f32_16x16x32_bf16 v[20:23], v[240:243], v[56:59], v[20:23]
  v_mfma_f32_16x16x32_bf16 v[32:35], v[240:243], v[60:63], v[32:35]
  v_mfma_f32_16x16x32_bf16 v[32:35], v[252:255], v[64:67], v[32:35]
  s_waitcnt lgkmcnt(8)
  s_barrier
  v_mfma_f32_16x16x32_bf16 v[0:3], v[208:211], v[60:63], v[0:3]
  ds_read_b128 v[36:39], v112 offset:51200
  v_mfma_f32_16x16x32_bf16 v[0:3], v[220:223], v[64:67], v[0:3]
  ds_read_b128 v[40:43], v113 offset:51200
  v_mfma_f32_16x16x32_bf16 v[12:15], v[220:223], v[68:71], v[12:15]
  ds_read_b128 v[44:47], v114 offset:51200
  v_mfma_f32_16x16x32_bf16 v[12:15], v[208:211], v[64:67], v[12:15]
  ds_read_b128 v[48:51], v115 offset:51200
  v_mfma_f32_16x16x32_bf16 v[24:27], v[208:211], v[68:71], v[24:27]
  ds_read_b128 v[52:55], v116 offset:51200
  v_mfma_f32_16x16x32_bf16 v[24:27], v[220:223], v[72:75], v[24:27]
  ds_read_b64_tr_b16 v[232:233], v128 offset:24576
  s_waitcnt lgkmcnt(10)
  v_mfma_f32_16x16x32_bf16 v[28:31], v[224:227], v[72:75], v[28:31]
  ds_read_b64_tr_b16 v[234:235], v128 offset:25344
  v_mfma_f32_16x16x32_bf16 v[28:31], v[212:215], v[68:71], v[28:31]
  ds_read_b64_tr_b16 v[236:237], v128 offset:27648
  v_mfma_f32_16x16x32_bf16 v[16:19], v[212:215], v[64:67], v[16:19]
  ds_read_b64_tr_b16 v[238:239], v128 offset:28416
  v_mfma_f32_16x16x32_bf16 v[16:19], v[224:227], v[68:71], v[16:19]
  ds_read_b64_tr_b16 v[240:241], v128 offset:30720
  v_mfma_f32_16x16x32_bf16 v[4:7], v[224:227], v[64:67], v[4:7]
  ds_read_b64_tr_b16 v[242:243], v128 offset:31488
  v_mfma_f32_16x16x32_bf16 v[4:7], v[212:215], v[60:63], v[4:7]
  ds_read_b64_tr_b16 v[244:245], v128 offset:33792
  s_waitcnt lgkmcnt(12)
  s_barrier
  v_mfma_f32_16x16x32_bf16 v[8:11], v[216:219], v[60:63], v[8:11]
  ds_read_b64_tr_b16 v[246:247], v128 offset:34560
  v_mfma_f32_16x16x32_bf16 v[8:11], v[228:231], v[64:67], v[8:11]
  v_mfma_f32_16x16x32_bf16 v[20:23], v[228:231], v[68:71], v[20:23]
  v_mfma_f32_16x16x32_bf16 v[20:23], v[216:219], v[64:67], v[20:23]
  v_mfma_f32_16x16x32_bf16 v[32:35], v[216:219], v[68:71], v[32:35]
  v_mfma_f32_16x16x32_bf16 v[32:35], v[228:231], v[72:75], v[32:35]
L_epi:
  s_waitcnt lgkmcnt(6)
  s_barrier
  v_mfma_f32_16x16x32_bf16 v[0:3], v[232:235], v[36:39], v[0:3]
  ds_read_b128 v[56:59], v117 offset:51200
  ds_read_b128 v[60:63], v118 offset:51200
  v_mfma_f32_16x16x32_bf16 v[12:15], v[232:235], v[40:43], v[12:15]
  ds_read_b64_tr_b16 v[248:249], v128 offset:36864
  v_mfma_f32_16x16x32_bf16 v[24:27], v[232:235], v[44:47], v[24:27]
  ds_read_b64_tr_b16 v[250:251], v128 offset:37632
  s_waitcnt lgkmcnt(8)
  v_mfma_f32_16x16x32_bf16 v[24:27], v[236:239], v[48:51], v[24:27]
  ds_read_b128 v[64:67], v119 offset:51200
  ds_read_b128 v[68:71], v112 offset:51712
  v_mfma_f32_16x16x32_bf16 v[12:15], v[236:239], v[44:47], v[12:15]
  ds_read_b64_tr_b16 v[252:253], v128 offset:39936
  v_mfma_f32_16x16x32_bf16 v[0:3], v[236:239], v[40:43], v[0:3]
  ds_read_b64_tr_b16 v[254:255], v128 offset:40704
  s_waitcnt lgkmcnt(10)
  v_mfma_f32_16x16x32_bf16 v[0:3], v[240:243], v[44:47], v[0:3]
  ds_read_b128 v[160:163], v112 offset:0
  ds_read_b128 v[164:167], v113 offset:0
  v_mfma_f32_16x16x32_bf16 v[12:15], v[240:243], v[48:51], v[12:15]
  ds_read_b64_tr_b16 v[208:209], v128 offset:43008
  v_mfma_f32_16x16x32_bf16 v[24:27], v[240:243], v[52:55], v[24:27]
  ds_read_b64_tr_b16 v[210:211], v128 offset:43776
  s_waitcnt lgkmcnt(11)
  v_mfma_f32_16x16x32_bf16 v[24:27], v[244:247], v[56:59], v[24:27]
  ds_read_b128 v[168:171], v114 offset:0
  ds_read_b128 v[172:175], v115 offset:0
  v_mfma_f32_16x16x32_bf16 v[12:15], v[244:247], v[52:55], v[12:15]
  ds_read_b64_tr_b16 v[212:213], v128 offset:0
  v_mfma_f32_16x16x32_bf16 v[0:3], v[244:247], v[48:51], v[0:3]
  ds_read_b64_tr_b16 v[214:215], v128 offset:768
  s_waitcnt lgkmcnt(12)
  s_barrier
  v_mfma_f32_16x16x32_bf16 v[0:3], v[248:251], v[52:55], v[0:3]
  ds_read_b128 v[176:179], v116 offset:0
  v_mfma_f32_16x16x32_bf16 v[12:15], v[248:251], v[56:59], v[12:15]
  ds_read_b64_tr_b16 v[216:217], v128 offset:3072
  v_mfma_f32_16x16x32_bf16 v[24:27], v[248:251], v[60:63], v[24:27]
  ds_read_b64_tr_b16 v[218:219], v128 offset:3840
  s_waitcnt lgkmcnt(11)
  v_mfma_f32_16x16x32_bf16 v[24:27], v[252:255], v[64:67], v[24:27]
  ds_read_b128 v[180:183], v117 offset:0
  v_mfma_f32_16x16x32_bf16 v[12:15], v[252:255], v[60:63], v[12:15]
  ds_read_b64_tr_b16 v[220:221], v128 offset:6144
  v_mfma_f32_16x16x32_bf16 v[0:3], v[252:255], v[56:59], v[0:3]
  ds_read_b64_tr_b16 v[222:223], v128 offset:6912
  s_waitcnt lgkmcnt(10)
  v_mfma_f32_16x16x32_bf16 v[0:3], v[208:211], v[60:63], v[0:3]
  ds_read_b128 v[184:187], v118 offset:0
  v_mfma_f32_16x16x32_bf16 v[12:15], v[208:211], v[64:67], v[12:15]
  ds_read_b64_tr_b16 v[224:225], v128 offset:9216
  v_mfma_f32_16x16x32_bf16 v[24:27], v[208:211], v[68:71], v[24:27]
  ds_read_b64_tr_b16 v[226:227], v128 offset:9984
  s_waitcnt lgkmcnt(9)
  v_mfma_f32_16x16x32_bf16 v[24:27], v[212:215], v[168:171], v[24:27]
  ds_read_b128 v[188:191], v119 offset:0
  v_mfma_f32_16x16x32_bf16 v[12:15], v[212:215], v[164:167], v[12:15]
  ds_read_b64_tr_b16 v[228:229], v128 offset:12288
  v_mfma_f32_16x16x32_bf16 v[0:3], v[212:215], v[160:163], v[0:3]
  ds_read_b64_tr_b16 v[230:231], v128 offset:13056
  s_waitcnt lgkmcnt(9)
  s_barrier
  v_mfma_f32_16x16x32_bf16 v[0:3], v[216:219], v[164:167], v[0:3]
  ds_read_b128 v[192:195], v112 offset:512
  v_mfma_f32_16x16x32_bf16 v[12:15], v[216:219], v[168:171], v[12:15]
  ds_read_b64_tr_b16 v[232:233], v128 offset:15360
  v_mfma_f32_16x16x32_bf16 v[24:27], v[216:219], v[172:175], v[24:27]
  ds_read_b64_tr_b16 v[234:235], v128 offset:16128
  s_waitcnt lgkmcnt(9)
  v_mfma_f32_16x16x32_bf16 v[24:27], v[220:223], v[176:179], v[24:27]
  ds_read_b128 v[196:199], v113 offset:512
  v_mfma_f32_16x16x32_bf16 v[12:15], v[220:223], v[172:175], v[12:15]
  ds_read_b64_tr_b16 v[236:237], v128 offset:18432
  v_mfma_f32_16x16x32_bf16 v[0:3], v[220:223], v[168:171], v[0:3]
  ds_read_b64_tr_b16 v[238:239], v128 offset:19200
  s_waitcnt lgkmcnt(9)
  v_mfma_f32_16x16x32_bf16 v[0:3], v[224:227], v[172:175], v[0:3]
  ds_read_b64_tr_b16 v[240:241], v128 offset:21504
  v_mfma_f32_16x16x32_bf16 v[12:15], v[224:227], v[176:179], v[12:15]
  ds_read_b64_tr_b16 v[242:243], v128 offset:22272
  v_mfma_f32_16x16x32_bf16 v[24:27], v[224:227], v[180:183], v[24:27]
  s_waitcnt lgkmcnt(8)
  v_mfma_f32_16x16x32_bf16 v[24:27], v[228:231], v[184:187], v[24:27]
  ds_read_b64_tr_b16 v[244:245], v128 offset:24608
  v_mfma_f32_16x16x32_bf16 v[12:15], v[228:231], v[180:183], v[12:15]
  ds_read_b64_tr_b16 v[246:247], v128 offset:25376
  v_mfma_f32_16x16x32_bf16 v[0:3], v[228:231], v[176:179], v[0:3]
  s_waitcnt lgkmcnt(7)
  v_mfma_f32_16x16x32_bf16 v[0:3], v[232:235], v[180:183], v[0:3]
  ds_read_b64_tr_b16 v[248:249], v128 offset:27680
  v_mfma_f32_16x16x32_bf16 v[12:15], v[232:235], v[184:187], v[12:15]
  ds_read_b64_tr_b16 v[250:251], v128 offset:28448
  v_mfma_f32_16x16x32_bf16 v[24:27], v[232:235], v[188:191], v[24:27]
  s_waitcnt lgkmcnt(6)
  v_mfma_f32_16x16x32_bf16 v[24:27], v[236:239], v[192:195], v[24:27]
  ds_read_b64_tr_b16 v[252:253], v128 offset:30752
  v_mfma_f32_16x16x32_bf16 v[12:15], v[236:239], v[188:191], v[12:15]
  ds_read_b64_tr_b16 v[254:255], v128 offset:31520
  v_mfma_f32_16x16x32_bf16 v[0:3], v[236:239], v[184:187], v[0:3]
  s_waitcnt lgkmcnt(6)
  v_mfma_f32_16x16x32_bf16 v[0:3], v[240:243], v[188:191], v[0:3]
  ds_read_b64_tr_b16 v[208:209], v128 offset:33824
  v_mfma_f32_16x16x32_bf16 v[12:15], v[240:243], v[192:195], v[12:15]
  ds_read_b64_tr_b16 v[210:211], v128 offset:34592
  v_mfma_f32_16x16x32_bf16 v[24:27], v[240:243], v[196:199], v[24:27]
  s_waitcnt lgkmcnt(6)
  v_mfma_f32_16x16x32_bf16 v[28:31], v[244:247], v[44:47], v[28:31]
  ds_read_b64_tr_b16 v[212:213], v128 offset:36896
  v_mfma_f32_16x16x32_bf16 v[16:19], v[244:247], v[40:43], v[16:19]
  ds_read_b64_tr_b16 v[214:215], v128 offset:37664
  v_mfma_f32_16x16x32_bf16 v[4:7], v[244:247], v[36:39], v[4:7]
  s_waitcnt lgkmcnt(6)
  v_mfma_f32_16x16x32_bf16 v[4:7], v[248:251], v[40:43], v[4:7]
  ds_read_b64_tr_b16 v[216:217], v128 offset:39968
  s_cmp_eq_u32 s22, 41
  s_cbranch_scc1 L_c_mask0
L_c_masked0:
  v_mfma_f32_16x16x32_bf16 v[16:19], v[248:251], v[44:47], v[16:19]
  ds_read_b64_tr_b16 v[218:219], v128 offset:40736
  v_mul_f32 v204, v0, v0
  v_mul_f32 v205, v1, v1
  v_mfma_f32_16x16x32_bf16 v[28:31], v[248:251], v[48:51], v[28:31]
  v_mul_f32 v206, v2, v2
  v_mul_f32 v207, v3, v3
  s_waitcnt lgkmcnt(6)
  v_mfma_f32_16x16x32_bf16 v[28:31], v[252:255], v[52:55], v[28:31]
  ds_read_b64_tr_b16 v[220:221], v128 offset:43040
  v_add_f32 v200, v0, v12
  v_add_f32 v201, v1, v13
  v_mfma_f32_16x16x32_bf16 v[16:19], v[252:255], v[48:51], v[16:19]
  ds_read_b64_tr_b16 v[222:223], v128 offset:43808
  v_add_f32 v202, v2, v14
  v_add_f32 v203, v3, v15
  v_mfma_f32_16x16x32_bf16 v[4:7], v[252:255], v[44:47], v[4:7]
  v_fmac_f32 v204, v12, v12
  v_fmac_f32 v205, v13, v13
  s_waitcnt lgkmcnt(6)
  v_mfma_f32_16x16x32_bf16 v[4:7], v[208:211], v[48:51], v[4:7]
  ds_read_b64_tr_b16 v[224:225], v128 offset:32
  v_fmac_f32 v206, v14, v14
  v_fmac_f32 v207, v15, v15
  v_mfma_f32_16x16x32_bf16 v[16:19], v[208:211], v[52:55], v[16:19]
  ds_read_b64_tr_b16 v[226:227], v128 offset:800
  v_add_f32 v200, v200, v24
  v_add_f32 v201, v201, v25
  v_mfma_f32_16x16x32_bf16 v[28:31], v[208:211], v[56:59], v[28:31]
  v_add_f32 v202, v202, v26
  v_add_f32 v203, v203, v27
  s_waitcnt lgkmcnt(6)
  v_mfma_f32_16x16x32_bf16 v[28:31], v[212:215], v[60:63], v[28:31]
  ds_read_b64_tr_b16 v[228:229], v128 offset:3104
  v_fmac_f32 v204, v24, v24
  v_fmac_f32 v205, v25, v25
  v_mfma_f32_16x16x32_bf16 v[16:19], v[212:215], v[56:59], v[16:19]
  ds_read_b64_tr_b16 v[230:231], v128 offset:3872
  v_fmac_f32 v206, v26, v26
  v_fmac_f32 v207, v27, v27
  v_mfma_f32_16x16x32_bf16 v[4:7], v[212:215], v[52:55], v[4:7]
  v_add_f32_dpp v152, v200, v200 row_shl:8 row_mask:0xf bank_mask:0x3
  v_add_f32_dpp v152, v201, v201 row_shr:8 row_mask:0xf bank_mask:0xc
  s_waitcnt lgkmcnt(6)
  v_mfma_f32_16x16x32_bf16 v[4:7], v[216:219], v[56:59], v[4:7]
  ds_read_b64_tr_b16 v[232:233], v128 offset:6176
  v_add_f32_dpp v153, v202, v202 row_shl:8 row_mask:0xf bank_mask:0x3
  v_add_f32_dpp v153, v203, v203 row_shr:8 row_mask:0xf bank_mask:0xc
  v_mfma_f32_16x16x32_bf16 v[16:19], v[216:219], v[60:63], v[16:19]
  ds_read_b64_tr_b16 v[234:235], v128 offset:6944
  v_add_f32_dpp v154, v204, v204 row_shl:8 row_mask:0xf bank_mask:0x3
  v_add_f32_dpp v154, v205, v205 row_shr:8 row_mask:0xf bank_mask:0xc
  v_mfma_f32_16x16x32_bf16 v[28:31], v[216:219], v[64:67], v[28:31]
  v_add_f32_dpp v155, v206, v206 row_shl:8 row_mask:0xf bank_mask:0x3
  v_add_f32_dpp v155, v207, v207 row_shr:8 row_mask:0xf bank_mask:0xc
  s_waitcnt lgkmcnt(6)
  v_mfma_f32_16x16x32_bf16 v[28:31], v[220:223], v[68:71], v[28:31]
  ds_read_b64_tr_b16 v[236:237], v128 offset:9248
  v_add_f32_dpp v156, v152, v152 row_shl:4 row_mask:0xf bank_mask:0x5
  v_add_f32_dpp v157, v153, v153 row_shl:4 row_mask:0xf bank_mask:0x5
  v_mfma_f32_16x16x32_bf16 v[16:19], v[220:223], v[64:67], v[16:19]
  ds_read_b64_tr_b16 v[238:239], v128 offset:10016
  v_add_f32_dpp v156, v154, v154 row_shr:4 row_mask:0xf bank_mask:0xa
  v_add_f32_dpp v157, v155, v155 row_shr:4 row_mask:0xf bank_mask:0xa
  v_mfma_f32_16x16x32_bf16 v[4:7], v[220:223], v[60:63], v[4:7]
  v_add_f32_dpp v156, v156, v156 quad_perm:[2,3,0,1] row_mask:0xf bank_mask:0xf
  v_add_f32_dpp v157, v157, v157 quad_perm:[2,3,0,1] row_mask:0xf bank_mask:0xf
  s_waitcnt lgkmcnt(6)
  v_mfma_f32_16x16x32_bf16 v[4:7], v[224:227], v[160:163], v[4:7]
  ds_read_b64_tr_b16 v[240:241], v128 offset:12320
  v_add_f32_dpp v156, v156, v156 quad_perm:[1,0,3,2] row_mask:0xf bank_mask:0xf
  v_add_f32_dpp v157, v157, v157 quad_perm:[1,0,3,2] row_mask:0xf bank_mask:0xf
  v_mfma_f32_16x16x32_bf16 v[16:19], v[224:227], v[164:167], v[16:19]
  ds_read_b64_tr_b16 v[242:243], v128 offset:13088
  ds_write2_b32 v132, v156, v157 offset0:0 offset1:4
  v_mfma_f32_16x16x32_bf16 v[28:31], v[224:227], v[168:171], v[28:31]
  s_waitcnt lgkmcnt(7)
  v_mfma_f32_16x16x32_bf16 v[28:31], v[228:231], v[172:175], v[28:31]
  ds_read_b64_tr_b16 v[244:245], v128 offset:15392
  v_mfma_f32_16x16x32_bf16 v[16:19], v[228:231], v[168:171], v[16:19]
  ds_read_b64_tr_b16 v[246:247], v128 offset:16160
  v_mfma_f32_16x16x32_bf16 v[4:7], v[228:231], v[164:167], v[4:7]
  s_waitcnt lgkmcnt(7)
  s_waitcnt lgkmcnt(2)
  s_barrier
  v_mfma_f32_16x16x32_bf16 v[4:7], v[232:235], v[168:171], v[4:7]
  ds_read_b64_tr_b16 v[248:249], v128 offset:18464
  v_mfma_f32_16x16x32_bf16 v[16:19], v[232:235], v[172:175], v[16:19]
  ds_read_b64_tr_b16 v[250:251], v128 offset:19232
  v_mfma_f32_16x16x32_bf16 v[28:31], v[232:235], v[176:179], v[28:31]
  v_mfma_f32_16x16x32_bf16 v[28:31], v[236:239], v[180:183], v[28:31]
  ds_read_b64_tr_b16 v[252:253], v128 offset:21536
  v_mfma_f32_16x16x32_bf16 v[16:19], v[236:239], v[176:179], v[16:19]
  ds_read_b64_tr_b16 v[254:255], v128 offset:22304
  v_mfma_f32_16x16x32_bf16 v[4:7], v[236:239], v[172:175], v[4:7]
  v_mfma_f32_16x16x32_bf16 v[4:7], v[240:243], v[176:179], v[4:7]
  ds_read_b64_tr_b16 v[208:209], v128 offset:24640
  v_mfma_f32_16x16x32_bf16 v[16:19], v[240:243], v[180:183], v[16:19]
  ds_read_b64_tr_b16 v[210:211], v128 offset:25408
  v_mfma_f32_16x16x32_bf16 v[28:31], v[240:243], v[184:187], v[28:31]
  s_waitcnt lgkmcnt(6)
  v_mfma_f32_16x16x32_bf16 v[28:31], v[244:247], v[188:191], v[28:31]
  ds_read_b64_tr_b16 v[212:213], v128 offset:27712
  v_mfma_f32_16x16x32_bf16 v[16:19], v[244:247], v[184:187], v[16:19]
  ds_read_b64_tr_b16 v[214:215], v128 offset:28480
  v_mfma_f32_16x16x32_bf16 v[4:7], v[244:247], v[180:183], v[4:7]
  s_waitcnt lgkmcnt(6)
  v_mfma_f32_16x16x32_bf16 v[4:7], v[248:251], v[184:187], v[4:7]
  ds_read_b64_tr_b16 v[216:217], v128 offset:30784
  v_mfma_f32_16x16x32_bf16 v[16:19], v[248:251], v[188:191], v[16:19]
  ds_read_b64_tr_b16 v[218:219], v128 offset:31552
  v_mfma_f32_16x16x32_bf16 v[28:31], v[248:251], v[192:195], v[28:31]
  s_waitcnt lgkmcnt(6)
  v_mfma_f32_16x16x32_bf16 v[28:31], v[252:255], v[196:199], v[28:31]
  ds_read_b64_tr_b16 v[220:221], v128 offset:33856
  v_mfma_f32_16x16x32_bf16 v[16:19], v[252:255], v[192:195], v[16:19]
  ds_read_b64_tr_b16 v[222:223], v128 offset:34624
  v_mfma_f32_16x16x32_bf16 v[4:7], v[252:255], v[188:191], v[4:7]
  s_waitcnt lgkmcnt(6)
  v_mfma_f32_16x16x32_bf16 v[8:11], v[208:211], v[36:39], v[8:11]
  ds_read_b64_tr_b16 v[224:225], v128 offset:36928
  v_mfma_f32_16x16x32_bf16 v[20:23], v[208:211], v[40:43], v[20:23]
  ds_read_b64_tr_b16 v[226:227], v128 offset:37696
  v_mfma_f32_16x16x32_bf16 v[32:35], v[208:211], v[44:47], v[32:35]
  s_waitcnt lgkmcnt(6)
  v_mfma_f32_16x16x32_bf16 v[32:35], v[212:215], v[48:51], v[32:35]
  ds_read_b64_tr_b16 v[228:229], v128 offset:40000
  s_cmp_eq_u32 s22, 41
  s_cbranch_scc1 L_c_mask1
L_c_masked1:
  v_mfma_f32_16x16x32_bf16 v[20:23], v[212:215], v[44:47], v[20:23]
  ds_read_b64_tr_b16 v[230:231], v128 offset:40768
  v_mul_f32 v204, v4, v4
  v_mul_f32 v205, v5, v5
  v_mfma_f32_16x16x32_bf16 v[8:11], v[212:215], v[40:43], v[8:11]
  v_mul_f32 v206, v6, v6
  v_mul_f32 v207, v7, v7
  s_waitcnt lgkmcnt(6)
  v_mfma_f32_16x16x32_bf16 v[8:11], v[216:219], v[44:47], v[8:11]
  ds_read_b64_tr_b16 v[232:233], v128 offset:43072
  v_add_f32 v200, v4, v16
  v_add_f32 v201, v5, v17
  v_mfma_f32_16x16x32_bf16 v[20:23], v[216:219], v[48:51], v[20:23]
  ds_read_b64_tr_b16 v[234:235], v128 offset:43840
  v_add_f32 v202, v6, v18
  v_add_f32 v203, v7, v19
  v_mfma_f32_16x16x32_bf16 v[32:35], v[216:219], v[52:55], v[32:35]
  v_fmac_f32 v204, v16, v16
  v_fmac_f32 v205, v17, v17
  s_waitcnt lgkmcnt(6)
  v_mfma_f32_16x16x32_bf16 v[32:35], v[220:223], v[56:59], v[32:35]
  ds_read_b64_tr_b16 v[236:237], v128 offset:64
  v_fmac_f32 v206, v18, v18
  v_fmac_f32 v207, v19, v19
  v_mfma_f32_16x16x32_bf16 v[20:23], v[220:223], v[52:55], v[20:23]
  ds_read_b64_tr_b16 v[238:239], v128 offset:832
  v_add_f32 v200, v200, v28
  v_add_f32 v201, v201, v29
  v_mfma_f32_16x16x32_bf16 v[8:11], v[220:223], v[48:51], v[8:11]
  v_add_f32 v202, v202, v30
  v_add_f32 v203, v203, v31
  s_waitcnt lgkmcnt(6)
  v_mfma_f32_16x16x32_bf16 v[8:11], v[224:227], v[52:55], v[8:11]
  ds_read_b64_tr_b16 v[240:241], v128 offset:3136
  v_fmac_f32 v204, v28, v28
  v_fmac_f32 v205, v29, v29
  v_mfma_f32_16x16x32_bf16 v[20:23], v[224:227], v[56:59], v[20:23]
  ds_read_b64_tr_b16 v[242:243], v128 offset:3904
  v_fmac_f32 v206, v30, v30
  v_fmac_f32 v207, v31, v31
  v_mfma_f32_16x16x32_bf16 v[32:35], v[224:227], v[60:63], v[32:35]
  v_add_f32_dpp v152, v200, v200 row_shl:8 row_mask:0xf bank_mask:0x3
  v_add_f32_dpp v152, v201, v201 row_shr:8 row_mask:0xf bank_mask:0xc
  s_waitcnt lgkmcnt(6)
  v_mfma_f32_16x16x32_bf16 v[32:35], v[228:231], v[64:67], v[32:35]
  ds_read_b64_tr_b16 v[244:245], v128 offset:6208
  v_add_f32_dpp v153, v202, v202 row_shl:8 row_mask:0xf bank_mask:0x3
  v_add_f32_dpp v153, v203, v203 row_shr:8 row_mask:0xf bank_mask:0xc
  v_mfma_f32_16x16x32_bf16 v[20:23], v[228:231], v[60:63], v[20:23]
  ds_read_b64_tr_b16 v[246:247], v128 offset:6976
  v_add_f32_dpp v154, v204, v204 row_shl:8 row_mask:0xf bank_mask:0x3
  v_add_f32_dpp v154, v205, v205 row_shr:8 row_mask:0xf bank_mask:0xc
  v_mfma_f32_16x16x32_bf16 v[8:11], v[228:231], v[56:59], v[8:11]
  v_add_f32_dpp v155, v206, v206 row_shl:8 row_mask:0xf bank_mask:0x3
  v_add_f32_dpp v155, v207, v207 row_shr:8 row_mask:0xf bank_mask:0xc
  s_waitcnt lgkmcnt(6)
  v_mfma_f32_16x16x32_bf16 v[8:11], v[232:235], v[60:63], v[8:11]
  ds_read_b64_tr_b16 v[248:249], v128 offset:9280
  v_add_f32_dpp v156, v152, v152 row_shl:4 row_mask:0xf bank_mask:0x5
  v_add_f32_dpp v157, v153, v153 row_shl:4 row_mask:0xf bank_mask:0x5
  v_mfma_f32_16x16x32_bf16 v[20:23], v[232:235], v[64:67], v[20:23]
  ds_read_b64_tr_b16 v[250:251], v128 offset:10048
  v_add_f32_dpp v156, v154, v154 row_shr:4 row_mask:0xf bank_mask:0xa
  v_add_f32_dpp v157, v155, v155 row_shr:4 row_mask:0xf bank_mask:0xa
  v_mfma_f32_16x16x32_bf16 v[32:35], v[232:235], v[68:71], v[32:35]
  v_add_f32_dpp v156, v156, v156 quad_perm:[2,3,0,1] row_mask:0xf bank_mask:0xf
  v_add_f32_dpp v157, v157, v157 quad_perm:[2,3,0,1] row_mask:0xf bank_mask:0xf
  s_waitcnt lgkmcnt(6)
  v_mfma_f32_16x16x32_bf16 v[32:35], v[236:239], v[168:171], v[32:35]
  ds_read_b64_tr_b16 v[252:253], v128 offset:12352
  v_add_f32_dpp v156, v156, v156 quad_perm:[1,0,3,2] row_mask:0xf bank_mask:0xf
  v_add_f32_dpp v157, v157, v157 quad_perm:[1,0,3,2] row_mask:0xf bank_mask:0xf
  v_mfma_f32_16x16x32_bf16 v[20:23], v[236:239], v[164:167], v[20:23]
  ds_read_b64_tr_b16 v[254:255], v128 offset:13120
  ds_write2_b32 v132, v156, v157 offset0:32 offset1:36
  v_mfma_f32_16x16x32_bf16 v[8:11], v[236:239], v[160:163], v[8:11]
  s_waitcnt lgkmcnt(7)
  v_mfma_f32_16x16x32_bf16 v[8:11], v[240:243], v[164:167], v[8:11]
  ds_read_b64_tr_b16 v[208:209], v128 offset:15424
  v_mfma_f32_16x16x32_bf16 v[20:23], v[240:243], v[168:171], v[20:23]
  ds_read_b64_tr_b16 v[210:211], v128 offset:16192
  v_mfma_f32_16x16x32_bf16 v[32:35], v[240:243], v[172:175], v[32:35]
  s_waitcnt lgkmcnt(7)
  s_waitcnt lgkmcnt(2)
  s_barrier
  v_mfma_f32_16x16x32_bf16 v[32:35], v[244:247], v[176:179], v[32:35]
  ds_read_b64_tr_b16 v[212:213], v128 offset:18496
  v_mfma_f32_16x16x32_bf16 v[20:23], v[244:247], v[172:175], v[20:23]
  ds_read_b64_tr_b16 v[214:215], v128 offset:19264
  v_mfma_f32_16x16x32_bf16 v[8:11], v[244:247], v[168:171], v[8:11]
  v_mfma_f32_16x16x32_bf16 v[8:11], v[248:251], v[172:175], v[8:11]
  ds_read_b64_tr_b16 v[216:217], v128 offset:21568
  v_mfma_f32_16x16x32_bf16 v[20:23], v[248:251], v[176:179], v[20:23]
  ds_read_b64_tr_b16 v[218:219], v128 offset:22336
  v_mfma_f32_16x16x32_bf16 v[32:35], v[248:251], v[180:183], v[32:35]
  v_mfma_f32_16x16x32_bf16 v[32:35], v[252:255], v[184:187], v[32:35]
  v_mfma_f32_16x16x32_bf16 v[20:23], v[252:255], v[180:183], v[20:23]
  v_mfma_f32_16x16x32_bf16 v[8:11], v[252:255], v[176:179], v[8:11]
  s_waitcnt lgkmcnt(4)
  v_mfma_f32_16x16x32_bf16 v[8:11], v[208:211], v[180:183], v[8:11]
  v_mfma_f32_16x16x32_bf16 v[20:23], v[208:211], v[184:187], v[20:23]
  v_mfma_f32_16x16x32_bf16 v[32:35], v[208:211], v[188:191], v[32:35]
  s_waitcnt lgkmcnt(2)
  v_mfma_f32_16x16x32_bf16 v[32:35], v[212:215], v[192:195], v[32:35]
  v_mfma_f32_16x16x32_bf16 v[20:23], v[212:215], v[188:191], v[20:23]
  v_mfma_f32_16x16x32_bf16 v[8:11], v[212:215], v[184:187], v[8:11]
  s_waitcnt lgkmcnt(0)
  v_mfma_f32_16x16x32_bf16 v[8:11], v[216:219], v[188:191], v[8:11]
  v_mfma_f32_16x16x32_bf16 v[20:23], v[216:219], v[192:195], v[20:23]
  v_mfma_f32_16x16x32_bf16 v[32:35], v[216:219], v[196:199], v[32:35]
  s_nop 3
  s_nop 0
  s_nop 0
  s_cmp_eq_u32 s22, 41
  s_cbranch_scc1 L_c_mask2
L_c_masked2:
  v_pk_mul_f32 v[204:205], v[8:9], v[8:9]
  v_pk_mul_f32 v[206:207], v[10:11], v[10:11]
  v_pk_add_f32 v[200:201], v[8:9], v[20:21]
  v_pk_add_f32 v[202:203], v[10:11], v[22:23]
  v_pk_fma_f32 v[204:205], v[20:21], v[20:21], v[204:205]
  v_pk_fma_f32 v[206:207], v[22:23], v[22:23], v[206:207]
  v_pk_add_f32 v[200:201], v[200:201], v[32:33]
  v_pk_add_f32 v[202:203], v[202:203], v[34:35]
  v_pk_fma_f32 v[204:205], v[32:33], v[32:33], v[204:205]
  v_pk_fma_f32 v[206:207], v[34:35], v[34:35], v[206:207]
  v_add_f32_dpp v152, v200, v200 row_shl:8 row_mask:0xf bank_mask:0x3
  v_add_f32_dpp v152, v201, v201 row_shr:8 row_mask:0xf bank_mask:0xc
  v_add_f32_dpp v153, v202, v202 row_shl:8 row_mask:0xf bank_mask:0x3
  v_add_f32_dpp v153, v203, v203 row_shr:8 row_mask:0xf bank_mask:0xc
  v_add_f32_dpp v154, v204, v204 row_shl:8 row_mask:0xf bank_mask:0x3
  v_add_f32_dpp v154, v205, v205 row_shr:8 row_mask:0xf bank_mask:0xc
  v_add_f32_dpp v155, v206, v206 row_shl:8 row_mask:0xf bank_mask:0x3
  v_add_f32_dpp v155, v207, v207 row_shr:8 row_mask:0xf bank_mask:0xc
  v_add_f32_dpp v156, v152, v152 row_shl:4 row_mask:0xf bank_mask:0x5
  v_add_f32_dpp v157, v153, v153 row_shl:4 row_mask:0xf bank_mask:0x5
  v_add_f32_dpp v156, v154, v154 row_shr:4 row_mask:0xf bank_mask:0xa
  v_add_f32_dpp v157, v155, v155 row_shr:4 row_mask:0xf bank_mask:0xa
  s_nop 0
  v_add_f32_dpp v156, v156, v156 quad_perm:[2,3,0,1] row_mask:0xf bank_mask:0xf
  v_add_f32_dpp v157, v157, v157 quad_perm:[2,3,0,1] row_mask:0xf bank_mask:0xf
  s_nop 0
  v_add_f32_dpp v156, v156, v156 quad_perm:[1,0,3,2] row_mask:0xf bank_mask:0xf
  v_add_f32_dpp v157, v157, v157 quad_perm:[1,0,3,2] row_mask:0xf bank_mask:0xf
  ds_write2_b32 v132, v156, v157 offset0:64 offset1:68
  s_waitcnt lgkmcnt(0)
  s_barrier
  s_barrier
L_c_wait0:
  ds_read_b32 v48, v134 offset:0
  ds_read_b128 v[40:43], v133 offset:0
  ds_read_b128 v[44:47], v133 offset:192
  s_waitcnt lgkmcnt(0)
  v_cmp_eq_u32 vcc, 0, v48
  v_pk_fma_f32 v[72:73], v[0:1], v[40:41], v[44:45]
  s_cbranch_vccnz L_c_wait0
  v_pk_fma_f32 v[74:75], v[2:3], v[42:43], v[46:47]
  v_pk_fma_f32 v[76:77], v[12:13], v[40:41], v[44:45]
  v_pk_fma_f32 v[78:79], v[14:15], v[42:43], v[46:47]
  v_pk_fma_f32 v[80:81], v[24:25], v[40:41], v[44:45]
  v_pk_fma_f32 v[82:83], v[26:27], v[42:43], v[46:47]
  v_pk_mul_f32 v[84:85], v[72:73], v[72:73]
  v_pk_mul_f32 v[86:87], v[74:75], v[74:75]
  v_pk_mul_f32 v[88:89], v[76:77], v[76:77]
  v_pk_mul_f32 v[90:91], v[78:79], v[78:79]
  v_pk_mul_f32 v[92:93], v[80:81], v[80:81]
  v_pk_mul_f32 v[94:95], v[82:83], v[82:83]
  v_pk_fma_f32 v[84:85], v[84:85], v[146:147], v[144:145]
  v_pk_fma_f32 v[86:87], v[86:87], v[146:147], v[144:145]
  v_pk_fma_f32 v[88:89], v[88:89], v[146:147], v[144:145]
  v_pk_fma_f32 v[90:91], v[90:91], v[146:147], v[144:145]
  v_pk_fma_f32 v[92:93], v[92:93], v[146:147], v[144:145]
  v_pk_fma_f32 v[94:95], v[94:95], v[146:147], v[144:145]
  v_pk_mul_f32 v[84:85], v[84:85], v[72:73]
  v_pk_mul_f32 v[86:87], v[86:87], v[74:75]
  v_pk_mul_f32 v[88:89], v[88:89], v[76:77]
  v_pk_mul_f32 v[90:91], v[90:91], v[78:79]
  v_pk_mul_f32 v[92:93], v[92:93], v[80:81]
  v_pk_mul_f32 v[94:95], v[94:95], v[82:83]
  v_exp_f32 v84, v84
  v_exp_f32 v85, v85
  v_exp_f32 v86, v86
  v_exp_f32 v87, v87
  v_exp_f32 v88, v88
  v_exp_f32 v89, v89
  v_exp_f32 v90, v90
  v_exp_f32 v91, v91
  v_exp_f32 v92, v92
  v_exp_f32 v93, v93
  v_exp_f32 v94, v94
  v_exp_f32 v95, v95
  v_pk_add_f32 v[84:85], v[84:85], v[148:149]
  v_pk_add_f32 v[86:87], v[86:87], v[148:149]
  v_pk_add_f32 v[88:89], v[88:89], v[148:149]
  v_pk_add_f32 v[90:91], v[90:91], v[148:149]
  v_pk_add_f32 v[92:93], v[92:93], v[148:149]
  v_pk_add_f32 v[94:95], v[94:95], v[148:149]
  v_rcp_f32 v84, v84
  v_rcp_f32 v85, v85
  v_rcp_f32 v86, v86
  v_rcp_f32 v87, v87
  s_nop 0
  v_pk_mul_f32 v[72:73], v[72:73], v[84:85]
  v_pk_mul_f32 v[74:75], v[74:75], v[86:87]
  v_cvt_pk_bf16_f32 v96, v72, v73
  v_cvt_pk_bf16_f32 v97, v74, v75
  v_rcp_f32 v88, v88
  v_rcp_f32 v89, v89
  v_rcp_f32 v90, v90
  v_rcp_f32 v91, v91
  buffer_store_dwordx2 v[96:97], v135, s[32:35], 0 offen offset:0
  v_pk_mul_f32 v[76:77], v[76:77], v[88:89]
  v_pk_mul_f32 v[78:79], v[78:79], v[90:91]
  v_cvt_pk_bf16_f32 v98, v76, v77
  v_cvt_pk_bf16_f32 v99, v78, v79
  v_rcp_f32 v92, v92
  v_rcp_f32 v93, v93
  v_rcp_f32 v94, v94
  v_rcp_f32 v95, v95
  buffer_store_dwordx2 v[98:99], v135, s[32:35], 0 offen offset:288
  v_pk_mul_f32 v[80:81], v[80:81], v[92:93]
  v_pk_mul_f32 v[82:83], v[82:83], v[94:95]
  v_cvt_pk_bf16_f32 v100, v80, v81
  v_cvt_pk_bf16_f32 v101, v82, v83
  buffer_store_dwordx2 v[100:101], v135, s[32:35], 0 offen offset:576
L_c_wait1:
  ds_read_b32 v48, v134 offset:4
  ds_read_b128 v[40:43], v133 offset:64
  ds_read_b128 v[44:47], v133 offset:256
  s_waitcnt lgkmcnt(0)
  v_cmp_eq_u32 vcc, 0, v48
  v_pk_fma_f32 v[72:73], v[4:5], v[40:41], v[44:45]
  s_cbranch_vccnz L_c_wait1
  v_pk_fma_f32 v[74:75], v[6:7], v[42:43], v[46:47]
  v_pk_fma_f32 v[76:77], v[16:17], v[40:41], v[44:45]
  v_pk_fma_f32 v[78:79], v[18:19], v[42:43], v[46:47]
  v_pk_fma_f32 v[80:81], v[28:29], v[40:41], v[44:45]
  v_pk_fma_f32 v[82:83], v[30:31], v[42:43], v[46:47]
  v_pk_mul_f32 v[84:85], v[72:73], v[72:73]
  v_pk_mul_f32 v[86:87], v[74:75], v[74:75]
  v_pk_mul_f32 v[88:89], v[76:77], v[76:77]
  v_pk_mul_f32 v[90:91], v[78:79], v[78:79]
  v_pk_mul_f32 v[92:93], v[80:81], v[80:81]
  v_pk_mul_f32 v[94:95], v[82:83], v[82:83]
  v_pk_fma_f32 v[84:85], v[84:85], v[146:147], v[144:145]
  v_pk_fma_f32 v[86:87], v[86:87], v[146:147], v[144:145]
  v_pk_fma_f32 v[88:89], v[88:89], v[146:147], v[144:145]
  v_pk_fma_f32 v[90:91], v[90:91], v[146:147], v[144:145]
  v_pk_fma_f32 v[92:93], v[92:93], v[146:147], v[144:145]
  v_pk_fma_f32 v[94:95], v[94:95], v[146:147], v[144:145]
  v_pk_mul_f32 v[84:85], v[84:85], v[72:73]
  v_pk_mul_f32 v[86:87], v[86:87], v[74:75]
  v_pk_mul_f32 v[88:89], v[88:89], v[76:77]
  v_pk_mul_f32 v[90:91], v[90:91], v[78:79]
  v_pk_mul_f32 v[92:93], v[92:93], v[80:81]
  v_pk_mul_f32 v[94:95], v[94:95], v[82:83]
  v_exp_f32 v84, v84
  v_exp_f32 v85, v85
  v_exp_f32 v86, v86
  v_exp_f32 v87, v87
  v_exp_f32 v88, v88
  v_exp_f32 v89, v89
  v_exp_f32 v90, v90
  v_exp_f32 v91, v91
  v_exp_f32 v92, v92
  v_exp_f32 v93, v93
  v_exp_f32 v94, v94
  v_exp_f32 v95, v95
  v_pk_add_f32 v[84:85], v[84:85], v[148:149]
  v_pk_add_f32 v[86:87], v[86:87], v[148:149]
  v_pk_add_f32 v[88:89], v[88:89], v[148:149]
  v_pk_add_f32 v[90:91], v[90:91], v[148:149]
  v_pk_add_f32 v[92:93], v[92:93], v[148:149]
  v_pk_add_f32 v[94:95], v[94:95], v[148:149]
  v_rcp_f32 v84, v84
  v_rcp_f32 v85, v85
  v_rcp_f32 v86, v86
  v_rcp_f32 v87, v87
  s_nop 0
  v_pk_mul_f32 v[72:73], v[72:73], v[84:85]
  v_pk_mul_f32 v[74:75], v[74:75], v[86:87]
  v_cvt_pk_bf16_f32 v102, v72, v73
  v_cvt_pk_bf16_f32 v103, v74, v75
  v_rcp_f32 v88, v88
  v_rcp_f32 v89, v89
  v_rcp_f32 v90, v90
  v_rcp_f32 v91, v91
  buffer_store_dwordx2 v[102:103], v135, s[32:35], 0 offen offset:32
  v_pk_mul_f32 v[76:77], v[76:77], v[88:89]
  v_pk_mul_f32 v[78:79], v[78:79], v[90:91]
  v_cvt_pk_bf16_f32 v104, v76, v77
  v_cvt_pk_bf16_f32 v105, v78, v79
  v_rcp_f32 v92, v92
  v_rcp_f32 v93, v93
  v_rcp_f32 v94, v94
  v_rcp_f32 v95, v95
  buffer_store_dwordx2 v[104:105], v135, s[32:35], 0 offen offset:320
  v_pk_mul_f32 v[80:81], v[80:81], v[92:93]
  v_pk_mul_f32 v[82:83], v[82:83], v[94:95]
  v_cvt_pk_bf16_f32 v106, v80, v81
  v_cvt_pk_bf16_f32 v107, v82, v83
  buffer_store_dwordx2 v[106:107], v135, s[32:35], 0 offen offset:608
L_c_wait2:
  ds_read_b32 v48, v134 offset:8
  ds_read_b128 v[40:43], v133 offset:128
  ds_read_b128 v[44:47], v133 offset:320
  s_waitcnt lgkmcnt(0)
  v_cmp_eq_u32 vcc, 0, v48
  v_pk_fma_f32 v[72:73], v[8:9], v[40:41], v[44:45]
  s_cbranch_vccnz L_c_wait2
  v_pk_fma_f32 v[74:75], v[10:11], v[42:43], v[46:47]
  v_pk_fma_f32 v[76:77], v[20:21], v[40:41], v[44:45]
  v_pk_fma_f32 v[78:79], v[22:23], v[42:43], v[46:47]
  v_pk_fma_f32 v[80:81], v[32:33], v[40:41], v[44:45]
  v_pk_fma_f32 v[82:83], v[34:35], v[42:43], v[46:47]
  v_pk_mul_f32 v[84:85], v[72:73], v[72:73]
  v_pk_mul_f32 v[86:87], v[74:75], v[74:75]
  v_pk_mul_f32 v[88:89], v[76:77], v[76:77]
  v_pk_mul_f32 v[90:91], v[78:79], v[78:79]
  v_pk_mul_f32 v[92:93], v[80:81], v[80:81]
  v_pk_mul_f32 v[94:95], v[82:83], v[82:83]
  v_pk_fma_f32 v[84:85], v[84:85], v[146:147], v[144:145]
  v_pk_fma_f32 v[86:87], v[86:87], v[146:147], v[144:145]
  v_pk_fma_f32 v[88:89], v[88:89], v[146:147], v[144:145]
  v_pk_fma_f32 v[90:91], v[90:91], v[146:147], v[144:145]
  v_pk_fma_f32 v[92:93], v[92:93], v[146:147], v[144:145]
  v_pk_fma_f32 v[94:95], v[94:95], v[146:147], v[144:145]
  v_pk_mul_f32 v[84:85], v[84:85], v[72:73]
  v_pk_mul_f32 v[86:87], v[86:87], v[74:75]
  v_pk_mul_f32 v[88:89], v[88:89], v[76:77]
  v_pk_mul_f32 v[90:91], v[90:91], v[78:79]
  v_pk_mul_f32 v[92:93], v[92:93], v[80:81]
  v_pk_mul_f32 v[94:95], v[94:95], v[82:83]
  v_exp_f32 v84, v84
  v_exp_f32 v85, v85
  v_exp_f32 v86, v86
  v_exp_f32 v87, v87
  v_exp_f32 v88, v88
  v_exp_f32 v89, v89
  v_exp_f32 v90, v90
  v_exp_f32 v91, v91
  v_exp_f32 v92, v92
  v_exp_f32 v93, v93
  v_exp_f32 v94, v94
  v_exp_f32 v95, v95
  v_pk_add_f32 v[84:85], v[84:85], v[148:149]
  v_pk_add_f32 v[86:87], v[86:87], v[148:149]
  v_pk_add_f32 v[88:89], v[88:89], v[148:149]
  v_pk_add_f32 v[90:91], v[90:91], v[148:149]
  v_pk_add_f32 v[92:93], v[92:93], v[148:149]
  v_pk_add_f32 v[94:95], v[94:95], v[148:149]
  v_rcp_f32 v84, v84
  v_rcp_f32 v85, v85
  v_rcp_f32 v86, v86
  v_rcp_f32 v87, v87
  s_nop 0
  v_pk_mul_f32 v[72:73], v[72:73], v[84:85]
  v_pk_mul_f32 v[74:75], v[74:75], v[86:87]
  v_cvt_pk_bf16_f32 v108, v72, v73
  v_cvt_pk_bf16_f32 v109, v74, v75
  v_rcp_f32 v88, v88
  v_rcp_f32 v89, v89
  v_rcp_f32 v90, v90
  v_rcp_f32 v91, v91
  buffer_store_dwordx2 v[108:109], v135, s[32:35], 0 offen offset:64
  v_pk_mul_f32 v[76:77], v[76:77], v[88:89]
  v_pk_mul_f32 v[78:79], v[78:79], v[90:91]
  v_cvt_pk_bf16_f32 v110, v76, v77
  v_cvt_pk_bf16_f32 v111, v78, v79
  v_rcp_f32 v92, v92
  v_rcp_f32 v93, v93
  v_rcp_f32 v94, v94
  v_rcp_f32 v95, v95
  buffer_store_dwordx2 v[110:111], v135, s[32:35], 0 offen offset:352
  v_pk_mul_f32 v[80:81], v[80:81], v[92:93]
  v_pk_mul_f32 v[82:83], v[82:83], v[94:95]
  v_cvt_pk_bf16_f32 v112, v80, v81
  v_cvt_pk_bf16_f32 v113, v82, v83
  buffer_store_dwordx2 v[112:113], v135, s[32:35], 0 offen offset:640
  s_endpgm
L_c_mask0:
  s_mov_b64 exec, s[70:71]
  v_mov_b64 v[0:1], 0
  v_mov_b64 v[2:3], 0
  s_mov_b64 exec, s[72:73]
  v_mov_b64 v[12:13], 0
  v_mov_b64 v[14:15], 0
  s_mov_b64 exec, s[74:75]
  v_mov_b64 v[24:25], 0
  v_mov_b64 v[26:27], 0
  s_mov_b64 exec, -1
  s_branch L_c_masked0
L_c_mask1:
  s_mov_b64 exec, s[70:71]
  v_mov_b64 v[4:5], 0
  v_mov_b64 v[6:7], 0
  s_mov_b64 exec, s[72:73]
  v_mov_b64 v[16:17], 0
  v_mov_b64 v[18:19], 0
  s_mov_b64 exec, s[74:75]
  v_mov_b64 v[28:29], 0
  v_mov_b64 v[30:31], 0
  s_mov_b64 exec, -1
  s_branch L_c_masked1
L_c_mask2:
  s_mov_b64 exec, s[70:71]
  v_mov_b64 v[8:9], 0
  v_mov_b64 v[10:11], 0
  s_mov_b64 exec, s[72:73]
  v_mov_b64 v[20:21], 0
  v_mov_b64 v[22:23], 0
  s_mov_b64 exec, s[74:75]
  v_mov_b64 v[32:33], 0
  v_mov_b64 v[34:35], 0
  s_mov_b64 exec, -1
  s_branch L_c_masked2
L_wepi:
  v_and_b32 v140, 7, v129
  v_lshlrev_b32 v140, 4, v140
  s_lshl_b32 s44, s49, 7
  v_add_u32 v140, s44, v140
  v_add_u32 v141, 161280, v140
  v_lshrrev_b32 v142, 3, v129
  v_mul_u32_u24 v142, 384, v142
  v_add_u32 v142, v142, v140
  s_mul_i32 s50, s22, 384
  v_lshlrev_b32 v143, 2, v135
  v_add_u32 v143, 162816, v143
  s_lshl_b32 s44, s49, 2
  s_add_u32 s44, s44, 163200
  v_mov_b32 v144, s44
  v_mov_b32 v145, 1
  s_mov_b32 s44, 0x39032fd1
  s_mov_b32 s45, 0
  s_movk_i32 s46, 3072
  s_movk_i32 s47, 9216
  s_movk_i32 s48, 15360
  s_waitcnt vmcnt(0)
  v_lshlrev_b32 v137, 16, v137
  v_lshlrev_b32 v138, 16, v138
  s_mov_b64 exec, 0xff
  s_mov_b32 s42, 0
L_w_e1:
  s_barrier
  s_cmp_lg_u32 s42, s49
  s_cbranch_scc1 L_w_nopub
  ds_read_b128 v[40:43], v141 offset:0
  ds_read_b128 v[44:47], v141 offset:384
  ds_read_b128 v[48:51], v141 offset:768
  ds_read_b128 v[52:55], v141 offset:1152
  s_waitcnt lgkmcnt(2)
  v_pk_add_f32 v[40:41], v[40:41], v[44:45]
  v_pk_add_f32 v[42:43], v[42:43], v[46:47]
  s_waitcnt lgkmcnt(0)
  v_pk_add_f32 v[48:49], v[48:49], v[52:53]
  v_pk_add_f32 v[50:51], v[50:51], v[54:55]
  v_pk_add_f32 v[40:41], v[40:41], v[48:49]
  v_pk_add_f32 v[42:43], v[42:43], v[50:51]
  v_min_u32 v40, -2, v40
  v_min_u32 v41, -2, v41
  v_min_u32 v42, -2, v42
  v_min_u32 v43, -2, v43
  buffer_store_dwordx4 v[40:43], v140, s[36:39], s50 offen sc1
L_w_nopub:
  s_add_u32 s42, s42, 1
  s_cmp_lt_u32 s42, 3
  s_cbranch_scc1 L_w_e1
  s_mov_b64 exec, -1
  s_barrier
  s_cmp_eq_u32 s49, 0
  s_cbranch_scc1 L_poll
  v_mov_b32 v146, 163200
L_chain:
  ds_read_b32 v147, v146
  s_waitcnt lgkmcnt(0)
  v_cmp_eq_u32 vcc, 0, v147
  s_nop 0
  s_cbranch_vccnz L_chain
L_poll:
  buffer_load_dwordx4 v[44:47], v142, s[36:39], 0 offen offset:0 sc1
  buffer_load_dwordx4 v[48:51], v142, s[36:39], s46 offen offset:0 sc1
  buffer_load_dwordx4 v[52:55], v142, s[36:39], s46 offen offset:3072 sc1
  buffer_load_dwordx4 v[56:59], v142, s[36:39], s47 offen offset:0 sc1
  buffer_load_dwordx4 v[60:63], v142, s[36:39], s47 offen offset:3072 sc1
  buffer_load_dwordx4 v[64:67], v142, s[36:39], s48 offen offset:0 sc1
L_pollwait:
  s_waitcnt vmcnt(4)
  v_pk_add_f32 v[68:69], v[44:45], v[48:49]
  v_pk_add_f32 v[70:71], v[46:47], v[50:51]
  s_waitcnt vmcnt(2)
  v_pk_add_f32 v[72:73], v[52:53], v[56:57]
  v_pk_add_f32 v[74:75], v[54:55], v[58:59]
  v_pk_add_f32 v[68:69], v[68:69], v[72:73]
  v_pk_add_f32 v[70:71], v[70:71], v[74:75]
  s_waitcnt vmcnt(0)
  v_pk_add_f32 v[72:73], v[60:61], v[64:65]
  v_pk_add_f32 v[74:75], v[62:63], v[66:67]
  v_pk_add_f32 v[68:69], v[68:69], v[72:73]
  v_pk_add_f32 v[70:71], v[70:71], v[74:75]
  v_cmp_u_f32 vcc, v68, v69
  v_cmp_u_f32 s[90:91], v70, v71
  s_nop 0
  s_or_b64 vcc, vcc, s[90:91]
  s_cbranch_vccnz L_recheck
L_polled:
  v_permlane32_swap_b32 v68, v70
  v_permlane32_swap_b32 v69, v71
  v_add_f32 v68, v68, v70
  v_add_f32 v69, v69, v71
  s_nop 1
  v_permlane16_swap_b32 v68, v69
  v_add_f32 v68, v68, v69
  s_nop 1
  v_add_f32_dpp v68, v68, v68 row_ror:8 row_mask:0xf bank_mask:0xf
  v_mul_f32 v68, s44, v68
  v_mov_b32 v69, v68
  s_nop 1
  v_permlane16_swap_b32 v68, v69
  v_fma_f32 v69, -v68, v68, v69
  v_max_f32 v69, 0, v69
  v_add_f32 v69, 0x3727c5ac, v69
  v_rsq_f32 v69, v69
  s_mov_b32 exec_lo, 0xff
  s_mov_b32 exec_hi, 0xff
  v_mul_f32 v69, v137, v69
  v_fma_f32 v68, -v68, v69, v138
  ds_write2_b32 v143, v69, v68 offset0:0 offset1:48
  ds_write_b32 v144, v145
  s_endpgm
L_recheck:
  v_max3_u32 v72, v44, v45, v46
  v_max3_u32 v73, v47, v48, v49
  v_max3_u32 v74, v50, v51, v52
  v_max3_u32 v75, v53, v54, v55
  v_max3_u32 v76, v56, v57, v58
  v_max3_u32 v77, v59, v60, v61
  v_max3_u32 v78, v62, v63, v64
  v_max3_u32 v79, v65, v66, v67
  v_max3_u32 v72, v72, v73, v74
  v_max3_u32 v75, v75, v76, v77
  v_max3_u32 v72, v72, v78, v79
  v_max_u32 v72, v72, v75
  v_cmp_eq_u32 vcc, -1, v72
  s_add_u32 s45, s45, 1
  s_cmp_ge_u32 s45, 0x100000
  s_cbranch_scc1 L_polled
  s_cbranch_vccnz L_poll
  s_branch L_polled
L_epi_end:
L_wmain0:
  s_waitcnt vmcnt(1)
  s_add_u32 m0, s51, 121344
  s_mov_b32 s50, 202752
  buffer_load_dwordx4 v139, s[28:31], s50 offen lds
  s_add_u32 m0, s51, 124416
  s_mov_b32 s50, 285696
  buffer_load_dwordx4 v139, s[28:31], s50 offen lds
  s_barrier
  s_add_u32 m0, s51, 127488
  s_mov_b32 s50, 368640
  buffer_load_dwordx4 v139, s[28:31], s50 offen lds
  s_add_u32 m0, s51, 130560
  s_mov_b32 s50, 451584
  buffer_load_dwordx4 v139, s[28:31], s50 offen lds
  s_add_u32 m0, s51, 133632
  s_mov_b32 s50, 534528
  buffer_load_dwordx4 v139, s[28:31], s50 offen lds
  s_add_u32 m0, s92, 12800
  s_add_u32 s50, s95, 128
  buffer_load_dwordx4 v131, s[24:27], s50 offen lds
  s_add_u32 m0, s92, 16896
  s_add_u32 s50, s95, 36992
  buffer_load_dwordx4 v131, s[24:27], s50 offen lds
  s_waitcnt vmcnt(6)
  s_barrier
  s_add_u32 m0, s92, 20992
  s_add_u32 s50, s95, 73856
  buffer_load_dwordx4 v131, s[24:27], s50 offen lds
  s_add_u32 m0, s51, 136704
  s_mov_b32 s50, 617472
  buffer_load_dwordx4 v139, s[28:31], s50 offen lds
  s_add_u32 m0, s51, 139776
  s_mov_b32 s50, 46080
  buffer_load_dwordx4 v139, s[28:31], s50 offen lds
  s_add_u32 m0, s51, 142848
  s_mov_b32 s50, 129024
  buffer_load_dwordx4 v139, s[28:31], s50 offen lds
  s_add_u32 m0, s51, 145920
  s_mov_b32 s50, 211968
  buffer_load_dwordx4 v139, s[28:31], s50 offen lds
  s_waitcnt vmcnt(9)
  s_barrier
  s_add_u32 m0, s51, 148992
  s_mov_b32 s50, 294912
  buffer_load_dwordx4 v139, s[28:31], s50 offen lds
  s_add_u32 m0, s51, 152064
  s_mov_b32 s50, 377856
  buffer_load_dwordx4 v139, s[28:31], s50 offen lds
  s_add_u32 m0, s51, 155136
  s_mov_b32 s50, 460800
  buffer_load_dwordx4 v139, s[28:31], s50 offen lds
  s_add_u32 m0, s51, 158208
  s_mov_b32 s50, 543744
  buffer_load_dwordx4 v139, s[28:31], s50 offen lds
  s_add_u32 m0, s51, 115200
  s_mov_b32 s50, 27648
  buffer_load_dwordx4 v139, s[28:31], s50 offen lds
  s_waitcnt vmcnt(12)
  s_barrier
  s_add_u32 m0, s51, 118272
  s_mov_b32 s50, 110592
  buffer_load_dwordx4 v139, s[28:31], s50 offen lds
  s_add_u32 m0, s51, 121344
  s_mov_b32 s50, 193536
  buffer_load_dwordx4 v139, s[28:31], s50 offen lds
  s_waitcnt vmcnt(9)
  s_barrier
  s_add_u32 m0, s51, 124416
  s_mov_b32 s50, 276480
  buffer_load_dwordx4 v139, s[28:31], s50 offen lds
  s_add_u32 m0, s51, 127488
  s_mov_b32 s50, 359424
  buffer_load_dwordx4 v139, s[28:31], s50 offen lds
  s_waitcnt vmcnt(9)
  s_barrier
  s_add_u32 m0, s51, 130560
  s_mov_b32 s50, 442368
  buffer_load_dwordx4 v139, s[28:31], s50 offen lds
  s_add_u32 m0, s51, 133632
  s_mov_b32 s50, 525312
  buffer_load_dwordx4 v139, s[28:31], s50 offen lds
  s_waitcnt vmcnt(9)
  s_barrier
  s_add_u32 m0, s51, 136704
  s_mov_b32 s50, 608256
  buffer_load_dwordx4 v139, s[28:31], s50 offen lds
  s_add_u32 m0, s51, 139776
  s_mov_b32 s50, 55296
  buffer_load_dwordx4 v139, s[28:31], s50 offen lds
  s_waitcnt vmcnt(9)
  s_barrier
  s_add_u32 m0, s51, 142848
  s_mov_b32 s50, 138240
  buffer_load_dwordx4 v139, s[28:31], s50 offen lds
  s_add_u32 m0, s51, 145920
  s_mov_b32 s50, 221184
  buffer_load_dwordx4 v139, s[28:31], s50 offen lds
  s_waitcnt vmcnt(9)
  s_barrier
  s_add_u32 m0, s51, 148992
  s_mov_b32 s50, 304128
  buffer_load_dwordx4 v139, s[28:31], s50 offen lds
  s_add_u32 m0, s51, 152064
  s_mov_b32 s50, 387072
  buffer_load_dwordx4 v139, s[28:31], s50 offen lds
  s_waitcnt vmcnt(9)
  s_barrier
  s_add_u32 m0, s92, 38400
  s_add_u32 s50, s95, 384
  buffer_load_dwordx4 v131, s[24:27], s50 offen lds
  s_add_u32 m0, s92, 42496
  s_add_u32 s50, s95, 37248
  buffer_load_dwordx4 v131, s[24:27], s50 offen lds
  s_add_u32 m0, s92, 46592
  s_add_u32 s50, s95, 74112
  buffer_load_dwordx4 v131, s[24:27], s50 offen lds
  s_add_u32 m0, s51, 155136
  s_mov_b32 s50, 470016
  buffer_load_dwordx4 v139, s[28:31], s50 offen lds
  s_add_u32 m0, s51, 158208
  s_mov_b32 s50, 552960
  buffer_load_dwordx4 v139, s[28:31], s50 offen lds
  s_waitcnt vmcnt(12)
  s_barrier
  s_add_u32 m0, s51, 115200
  s_mov_b32 s50, 18432
  buffer_load_dwordx4 v139, s[28:31], s50 offen lds
  s_add_u32 m0, s51, 118272
  s_mov_b32 s50, 101376
  buffer_load_dwordx4 v139, s[28:31], s50 offen lds
  s_waitcnt vmcnt(12)
  s_barrier
  s_add_u32 m0, s51, 121344
  s_mov_b32 s50, 184320
  buffer_load_dwordx4 v139, s[28:31], s50 offen lds
  s_add_u32 m0, s51, 124416
  s_mov_b32 s50, 267264
  buffer_load_dwordx4 v139, s[28:31], s50 offen lds
  s_waitcnt vmcnt(6)
  s_barrier
  s_add_u32 m0, s92, 64000
  s_add_u32 s50, s95, 640
  buffer_load_dwordx4 v131, s[24:27], s50 offen lds
  s_add_u32 m0, s92, 68096
  s_add_u32 s50, s95, 37504
  buffer_load_dwordx4 v131, s[24:27], s50 offen lds
  s_add_u32 m0, s51, 127488
  s_mov_b32 s50, 350208
  buffer_load_dwordx4 v139, s[28:31], s50 offen lds
  s_add_u32 m0, s51, 130560
  s_mov_b32 s50, 433152
  buffer_load_dwordx4 v139, s[28:31], s50 offen lds
  s_barrier
  s_add_u32 m0, s92, 72192
  s_add_u32 s50, s95, 74368
  buffer_load_dwordx4 v131, s[24:27], s50 offen lds
  s_add_u32 m0, s92, 102400
  s_add_u32 s50, s95, 1024
  buffer_load_dwordx4 v131, s[24:27], s50 offen lds
  s_add_u32 m0, s92, 106496
  s_add_u32 s50, s95, 37888
  buffer_load_dwordx4 v131, s[24:27], s50 offen lds
  s_add_u32 m0, s51, 133632
  s_mov_b32 s50, 516096
  buffer_load_dwordx4 v139, s[28:31], s50 offen lds
  s_add_u32 m0, s51, 136704
  s_mov_b32 s50, 599040
  buffer_load_dwordx4 v139, s[28:31], s50 offen lds
  s_waitcnt vmcnt(14)
  s_barrier
  s_add_u32 m0, s92, 110592
  s_add_u32 s50, s95, 74752
  buffer_load_dwordx4 v131, s[24:27], s50 offen lds
  s_add_u32 m0, s51, 139776
  s_mov_b32 s50, 64512
  buffer_load_dwordx4 v139, s[28:31], s50 offen lds
  s_add_u32 m0, s51, 142848
  s_mov_b32 s50, 147456
  buffer_load_dwordx4 v139, s[28:31], s50 offen lds
  s_waitcnt vmcnt(7)
  s_barrier
  s_add_u32 m0, s51, 145920
  s_mov_b32 s50, 230400
  buffer_load_dwordx4 v139, s[28:31], s50 offen lds
  s_add_u32 m0, s51, 148992
  s_mov_b32 s50, 313344
  buffer_load_dwordx4 v139, s[28:31], s50 offen lds
  s_barrier
  s_add_u32 m0, s51, 152064
  s_mov_b32 s50, 396288
  buffer_load_dwordx4 v139, s[28:31], s50 offen lds
  s_add_u32 m0, s51, 155136
  s_mov_b32 s50, 479232
  buffer_load_dwordx4 v139, s[28:31], s50 offen lds
  s_barrier
  s_add_u32 m0, s51, 158208
  s_mov_b32 s50, 562176
  buffer_load_dwordx4 v139, s[28:31], s50 offen lds
  s_add_u32 m0, s51, 115200
  s_mov_b32 s50, 9216
  buffer_load_dwordx4 v139, s[28:31], s50 offen lds
  s_waitcnt vmcnt(10)
  s_barrier
  s_add_u32 m0, s51, 118272
  s_mov_b32 s50, 92160
  buffer_load_dwordx4 v139, s[28:31], s50 offen lds
  s_add_u32 m0, s51, 121344
  s_mov_b32 s50, 175104
  buffer_load_dwordx4 v139, s[28:31], s50 offen lds
  s_waitcnt vmcnt(9)
  s_barrier
  s_add_u32 m0, s51, 124416
  s_mov_b32 s50, 258048
  buffer_load_dwordx4 v139, s[28:31], s50 offen lds
  s_add_u32 m0, s51, 127488
  s_mov_b32 s50, 340992
  buffer_load_dwordx4 v139, s[28:31], s50 offen lds
  s_waitcnt vmcnt(9)
  s_barrier
  s_add_u32 m0, s92, 0
  s_add_u32 s50, s95, 0
  buffer_load_dwordx4 v131, s[24:27], s50 offen lds
  s_add_u32 m0, s92, 4096
  s_add_u32 s50, s95, 36864
  buffer_load_dwordx4 v131, s[24:27], s50 offen lds
  s_add_u32 m0, s92, 8192
  s_add_u32 s50, s95, 73728
  buffer_load_dwordx4 v131, s[24:27], s50 offen lds
  s_add_u32 m0, s51, 130560
  s_mov_b32 s50, 423936
  buffer_load_dwordx4 v139, s[28:31], s50 offen lds
  s_add_u32 m0, s51, 133632
  s_mov_b32 s50, 506880
  buffer_load_dwordx4 v139, s[28:31], s50 offen lds
  s_waitcnt vmcnt(12)
  s_barrier
  s_add_u32 m0, s51, 136704
  s_mov_b32 s50, 589824
  buffer_load_dwordx4 v139, s[28:31], s50 offen lds
  s_add_u32 m0, s51, 139776
  s_mov_b32 s50, 73728
  buffer_load_dwordx4 v139, s[28:31], s50 offen lds
  s_waitcnt vmcnt(12)
  s_barrier
  s_add_u32 m0, s51, 142848
  s_mov_b32 s50, 156672
  buffer_load_dwordx4 v139, s[28:31], s50 offen lds
  s_add_u32 m0, s51, 145920
  s_mov_b32 s50, 239616
  buffer_load_dwordx4 v139, s[28:31], s50 offen lds
  s_waitcnt vmcnt(6)
  s_barrier
  s_add_u32 m0, s51, 148992
  s_mov_b32 s50, 322560
  buffer_load_dwordx4 v139, s[28:31], s50 offen lds
  s_add_u32 m0, s51, 152064
  s_mov_b32 s50, 405504
  buffer_load_dwordx4 v139, s[28:31], s50 offen lds
  s_barrier
  s_add_u32 m0, s92, 51200
  s_add_u32 s50, s95, 512
  buffer_load_dwordx4 v131, s[24:27], s50 offen lds
  s_add_u32 m0, s92, 55296
  s_add_u32 s50, s95, 37376
  buffer_load_dwordx4 v131, s[24:27], s50 offen lds
  s_add_u32 m0, s92, 59392
  s_add_u32 s50, s95, 74240
  buffer_load_dwordx4 v131, s[24:27], s50 offen lds
  s_add_u32 m0, s51, 155136
  s_mov_b32 s50, 488448
  buffer_load_dwordx4 v139, s[28:31], s50 offen lds
  s_add_u32 m0, s51, 158208
  s_mov_b32 s50, 571392
  buffer_load_dwordx4 v139, s[28:31], s50 offen lds
  s_waitcnt vmcnt(12)
  s_barrier
  s_add_u32 m0, s51, 115200
  s_mov_b32 s50, 0
  buffer_load_dwordx4 v139, s[28:31], s50 offen lds
  s_add_u32 m0, s51, 118272
  s_mov_b32 s50, 82944
  buffer_load_dwordx4 v139, s[28:31], s50 offen lds
  s_waitcnt vmcnt(12)
  s_barrier
  s_add_u32 m0, s51, 121344
  s_mov_b32 s50, 165888
  buffer_load_dwordx4 v139, s[28:31], s50 offen lds
  s_add_u32 m0, s51, 124416
  s_mov_b32 s50, 248832
  buffer_load_dwordx4 v139, s[28:31], s50 offen lds
  s_waitcnt vmcnt(6)
  s_barrier
  s_add_u32 m0, s51, 127488
  s_mov_b32 s50, 331776
  buffer_load_dwordx4 v139, s[28:31], s50 offen lds
  s_add_u32 m0, s51, 130560
  s_mov_b32 s50, 414720
  buffer_load_dwordx4 v139, s[28:31], s50 offen lds
  s_barrier
  s_add_u32 m0, s51, 133632
  s_mov_b32 s50, 497664
  buffer_load_dwordx4 v139, s[28:31], s50 offen lds
  s_add_u32 m0, s51, 136704
  s_mov_b32 s50, 580608
  buffer_load_dwordx4 v139, s[28:31], s50 offen lds
  buffer_load_ushort v137, v134, s[52:55], 0 offen
  buffer_load_ushort v138, v134, s[56:59], 0 offen
  s_waitcnt vmcnt(9)
  s_barrier
  s_waitcnt vmcnt(5)
  s_barrier
  s_waitcnt vmcnt(2)
  s_barrier
  s_branch L_wepi
L_xmain0:
  s_barrier
  s_add_u32 m0, s81, 89600
  s_add_u32 s50, s84, 896
  buffer_load_dwordx4 v131, s[24:27], s50 offen lds
  s_add_u32 m0, s81, 92672
  s_add_u32 s50, s84, 28544
  buffer_load_dwordx4 v131, s[24:27], s50 offen lds
  s_add_u32 m0, s81, 95744
  s_add_u32 s50, s84, 56192
  buffer_load_dwordx4 v131, s[24:27], s50 offen lds
  s_add_u32 m0, s81, 98816
  s_add_u32 s50, s84, 83840
  buffer_load_dwordx4 v131, s[24:27], s50 offen lds
  s_add_u32 m0, s92, 12800
  s_add_u32 s50, s95, 128
  buffer_load_dwordx4 v131, s[24:27], s50 offen lds
  s_add_u32 m0, s92, 16896
  s_add_u32 s50, s95, 36992
  buffer_load_dwordx4 v131, s[24:27], s50 offen lds
  s_barrier
  s_add_u32 m0, s82, 89600
  s_add_u32 s50, s85, 896
  buffer_load_dwordx4 v131, s[24:27], s50 offen lds
  s_add_u32 m0, s82, 92672
  s_add_u32 s50, s85, 28544
  buffer_load_dwordx4 v131, s[24:27], s50 offen lds
  s_add_u32 m0, s82, 95744
  s_add_u32 s50, s85, 56192
  buffer_load_dwordx4 v131, s[24:27], s50 offen lds
  s_add_u32 m0, s82, 98816
  s_add_u32 s50, s85, 83840
  buffer_load_dwordx4 v131, s[24:27], s50 offen lds
  s_add_u32 m0, s92, 20992
  s_add_u32 s50, s95, 73856
  buffer_load_dwordx4 v131, s[24:27], s50 offen lds
  s_mov_b32 m0, 25088
  s_mov_b32 s50, 110720
  s_mov_b32 exec_hi, 0
  buffer_load_dwordx4 v131, s[24:27], s50 offen lds
  s_mov_b32 exec_hi, -1
  s_barrier
  s_barrier
  s_waitcnt vmcnt(2)
  s_barrier
  s_barrier
  s_barrier
  s_barrier
  s_waitcnt vmcnt(0)
  s_barrier
  s_barrier
  s_add_u32 m0, s92, 38400
  s_add_u32 s50, s95, 384
  buffer_load_dwordx4 v131, s[24:27], s50 offen lds
  s_add_u32 m0, s92, 42496
  s_add_u32 s50, s95, 37248
  buffer_load_dwordx4 v131, s[24:27], s50 offen lds
  s_add_u32 m0, s92, 46592
  s_add_u32 s50, s95, 74112
  buffer_load_dwordx4 v131, s[24:27], s50 offen lds
  s_mov_b32 m0, 50688
  s_mov_b32 s50, 110976
  s_mov_b32 exec_hi, 0
  buffer_load_dwordx4 v131, s[24:27], s50 offen lds
  s_mov_b32 exec_hi, -1
  s_barrier
  s_barrier
  s_waitcnt vmcnt(0)
  s_barrier
  s_add_u32 m0, s92, 64000
  s_add_u32 s50, s95, 640
  buffer_load_dwordx4 v131, s[24:27], s50 offen lds
  s_add_u32 m0, s92, 68096
  s_add_u32 s50, s95, 37504
  buffer_load_dwordx4 v131, s[24:27], s50 offen lds
  s_barrier
  s_add_u32 m0, s92, 72192
  s_add_u32 s50, s95, 74368
  buffer_load_dwordx4 v131, s[24:27], s50 offen lds
  s_mov_b32 m0, 76288
  s_mov_b32 s50, 111232
  s_mov_b32 exec_hi, 0
  buffer_load_dwordx4 v131, s[24:27], s50 offen lds
  s_mov_b32 exec_hi, -1
  s_add_u32 m0, s92, 102400
  s_add_u32 s50, s95, 1024
  buffer_load_dwordx4 v131, s[24:27], s50 offen lds
  s_add_u32 m0, s92, 106496
  s_add_u32 s50, s95, 37888
  buffer_load_dwordx4 v131, s[24:27], s50 offen lds
  s_barrier
  s_add_u32 m0, s92, 110592
  s_add_u32 s50, s95, 74752
  buffer_load_dwordx4 v131, s[24:27], s50 offen lds
  s_mov_b32 m0, 114688
  s_mov_b32 s50, 111616
  s_mov_b32 exec_hi, 0
  buffer_load_dwordx4 v131, s[24:27], s50 offen lds
  s_mov_b32 exec_hi, -1
  s_waitcnt vmcnt(4)
  s_barrier
  s_barrier
  s_barrier
  s_barrier
  s_waitcnt vmcnt(0)
  s_barrier
  s_barrier
  s_add_u32 m0, s92, 0
  s_add_u32 s50, s95, 0
  buffer_load_dwordx4 v131, s[24:27], s50 offen lds
  s_add_u32 m0, s92, 4096
  s_add_u32 s50, s95, 36864
  buffer_load_dwordx4 v131, s[24:27], s50 offen lds
  s_add_u32 m0, s92, 8192
  s_add_u32 s50, s95, 73728
  buffer_load_dwordx4 v131, s[24:27], s50 offen lds
  s_mov_b32 m0, 12288
  s_mov_b32 s50, 110592
  s_mov_b32 exec_hi, 0
  buffer_load_dwordx4 v131, s[24:27], s50 offen lds
  s_mov_b32 exec_hi, -1
  s_barrier
  s_barrier
  s_waitcnt vmcnt(0)
  s_barrier
  s_barrier
  s_add_u32 m0, s92, 51200
  s_add_u32 s50, s95, 512
  buffer_load_dwordx4 v131, s[24:27], s50 offen lds
  s_add_u32 m0, s92, 55296
  s_add_u32 s50, s95, 37376
  buffer_load_dwordx4 v131, s[24:27], s50 offen lds
  s_add_u32 m0, s92, 59392
  s_add_u32 s50, s95, 74240
  buffer_load_dwordx4 v131, s[24:27], s50 offen lds
  s_mov_b32 m0, 63488
  s_mov_b32 s50, 111104
  s_mov_b32 exec_hi, 0
  buffer_load_dwordx4 v131, s[24:27], s50 offen lds
  s_mov_b32 exec_hi, -1
  s_barrier
  s_barrier
  s_waitcnt vmcnt(0)
  s_barrier
  s_barrier
  s_branch L_xtail
L_wmain1:
  s_waitcnt vmcnt(1)
  s_add_u32 m0, s51, 121344
  s_mov_b32 s50, 202752
  buffer_load_dwordx4 v139, s[28:31], s50 offen lds
  s_add_u32 m0, s51, 124416
  s_mov_b32 s50, 285696
  buffer_load_dwordx4 v139, s[28:31], s50 offen lds
  s_barrier
  s_add_u32 m0, s51, 127488
  s_mov_b32 s50, 368640
  buffer_load_dwordx4 v139, s[28:31], s50 offen lds
  s_add_u32 m0, s51, 130560
  s_mov_b32 s50, 451584
  buffer_load_dwordx4 v139, s[28:31], s50 offen lds
  s_add_u32 m0, s51, 133632
  s_mov_b32 s50, 534528
  buffer_load_dwordx4 v139, s[28:31], s50 offen lds
  s_waitcnt vmcnt(4)
  s_barrier
  s_add_u32 m0, s51, 136704
  s_mov_b32 s50, 617472
  buffer_load_dwordx4 v139, s[28:31], s50 offen lds
  s_add_u32 m0, s51, 139776
  s_mov_b32 s50, 46080
  buffer_load_dwordx4 v139, s[28:31], s50 offen lds
  s_add_u32 m0, s51, 142848
  s_mov_b32 s50, 129024
  buffer_load_dwordx4 v139, s[28:31], s50 offen lds
  s_add_u32 m0, s51, 145920
  s_mov_b32 s50, 211968
  buffer_load_dwordx4 v139, s[28:31], s50 offen lds
  s_add_u32 m0, s51, 148992
  s_mov_b32 s50, 294912
  buffer_load_dwordx4 v139, s[28:31], s50 offen lds
  s_waitcnt vmcnt(7)
  s_barrier
  s_add_u32 m0, s51, 152064
  s_mov_b32 s50, 377856
  buffer_load_dwordx4 v139, s[28:31], s50 offen lds
  s_add_u32 m0, s51, 155136
  s_mov_b32 s50, 460800
  buffer_load_dwordx4 v139, s[28:31], s50 offen lds
  s_add_u32 m0, s51, 158208
  s_mov_b32 s50, 543744
  buffer_load_dwordx4 v139, s[28:31], s50 offen lds
  s_add_u32 m0, s51, 115200
  s_mov_b32 s50, 27648
  buffer_load_dwordx4 v139, s[28:31], s50 offen lds
  s_waitcnt vmcnt(9)
  s_barrier
  s_add_u32 m0, s51, 118272
  s_mov_b32 s50, 110592
  buffer_load_dwordx4 v139, s[28:31], s50 offen lds
  s_add_u32 m0, s51, 121344
  s_mov_b32 s50, 193536
  buffer_load_dwordx4 v139, s[28:31], s50 offen lds
  s_waitcnt vmcnt(9)
  s_barrier
  s_add_u32 m0, s51, 124416
  s_mov_b32 s50, 276480
  buffer_load_dwordx4 v139, s[28:31], s50 offen lds
  s_add_u32 m0, s51, 127488
  s_mov_b32 s50, 359424
  buffer_load_dwordx4 v139, s[28:31], s50 offen lds
  s_waitcnt vmcnt(9)
  s_barrier
  s_add_u32 m0, s92, 12800
  s_add_u32 s50, s95, 128
  buffer_load_dwordx4 v131, s[24:27], s50 offen lds
  s_add_u32 m0, s92, 16896
  s_add_u32 s50, s95, 36992
  buffer_load_dwordx4 v131, s[24:27], s50 offen lds
  s_add_u32 m0, s92, 20992
  s_add_u32 s50, s95, 73856
  buffer_load_dwordx4 v131, s[24:27], s50 offen lds
  s_add_u32 m0, s51, 130560
  s_mov_b32 s50, 442368
  buffer_load_dwordx4 v139, s[28:31], s50 offen lds
  s_add_u32 m0, s51, 133632
  s_mov_b32 s50, 525312
  buffer_load_dwordx4 v139, s[28:31], s50 offen lds
  s_waitcnt vmcnt(12)
  s_barrier
  s_add_u32 m0, s92, 38400
  s_add_u32 s50, s95, 384
  buffer_load_dwordx4 v131, s[24:27], s50 offen lds
  s_add_u32 m0, s92, 42496
  s_add_u32 s50, s95, 37248
  buffer_load_dwordx4 v131, s[24:27], s50 offen lds
  s_add_u32 m0, s92, 46592
  s_add_u32 s50, s95, 74112
  buffer_load_dwordx4 v131, s[24:27], s50 offen lds
  s_add_u32 m0, s51, 136704
  s_mov_b32 s50, 608256
  buffer_load_dwordx4 v139, s[28:31], s50 offen lds
  s_add_u32 m0, s51, 139776
  s_mov_b32 s50, 55296
  buffer_load_dwordx4 v139, s[28:31], s50 offen lds
  s_waitcnt vmcnt(15)
  s_barrier
  s_add_u32 m0, s51, 142848
  s_mov_b32 s50, 138240
  buffer_load_dwordx4 v139, s[28:31], s50 offen lds
  s_add_u32 m0, s51, 145920
  s_mov_b32 s50, 221184
  buffer_load_dwordx4 v139, s[28:31], s50 offen lds
  s_waitcnt vmcnt(9)
  s_barrier
  s_add_u32 m0, s51, 148992
  s_mov_b32 s50, 304128
  buffer_load_dwordx4 v139, s[28:31], s50 offen lds
  s_add_u32 m0, s51, 152064
  s_mov_b32 s50, 387072
  buffer_load_dwordx4 v139, s[28:31], s50 offen lds
  s_barrier
  s_add_u32 m0, s51, 155136
  s_mov_b32 s50, 470016
  buffer_load_dwordx4 v139, s[28:31], s50 offen lds
  s_add_u32 m0, s51, 158208
  s_mov_b32 s50, 552960
  buffer_load_dwordx4 v139, s[28:31], s50 offen lds
  s_waitcnt vmcnt(12)
  s_barrier
  s_add_u32 m0, s51, 115200
  s_mov_b32 s50, 18432
  buffer_load_dwordx4 v139, s[28:31], s50 offen lds
  s_add_u32 m0, s51, 118272
  s_mov_b32 s50, 101376
  buffer_load_dwordx4 v139, s[28:31], s50 offen lds
  s_waitcnt vmcnt(9)
  s_barrier
  s_add_u32 m0, s51, 121344
  s_mov_b32 s50, 184320
  buffer_load_dwordx4 v139, s[28:31], s50 offen lds
  s_add_u32 m0, s51, 124416
  s_mov_b32 s50, 267264
  buffer_load_dwordx4 v139, s[28:31], s50 offen lds
  s_waitcnt vmcnt(9)
  s_barrier
  s_add_u32 m0, s92, 64000
  s_add_u32 s50, s95, 640
  buffer_load_dwordx4 v131, s[24:27], s50 offen lds
  s_add_u32 m0, s92, 68096
  s_add_u32 s50, s95, 37504
  buffer_load_dwordx4 v131, s[24:27], s50 offen lds
  s_add_u32 m0, s51, 127488
  s_mov_b32 s50, 350208
  buffer_load_dwordx4 v139, s[28:31], s50 offen lds
  s_add_u32 m0, s51, 130560
  s_mov_b32 s50, 433152
  buffer_load_dwordx4 v139, s[28:31], s50 offen lds
  s_waitcnt vmcnt(11)
  s_barrier
  s_add_u32 m0, s92, 72192
  s_add_u32 s50, s95, 74368
  buffer_load_dwordx4 v131, s[24:27], s50 offen lds
  s_add_u32 m0, s51, 133632
  s_mov_b32 s50, 516096
  buffer_load_dwordx4 v139, s[28:31], s50 offen lds
  s_add_u32 m0, s51, 136704
  s_mov_b32 s50, 599040
  buffer_load_dwordx4 v139, s[28:31], s50 offen lds
  s_waitcnt vmcnt(12)
  s_barrier
  s_add_u32 m0, s51, 139776
  s_mov_b32 s50, 64512
  buffer_load_dwordx4 v139, s[28:31], s50 offen lds
  s_add_u32 m0, s51, 142848
  s_mov_b32 s50, 147456
  buffer_load_dwordx4 v139, s[28:31], s50 offen lds
  s_waitcnt vmcnt(4)
  s_barrier
  s_add_u32 m0, s51, 145920
  s_mov_b32 s50, 230400
  buffer_load_dwordx4 v139, s[28:31], s50 offen lds
  s_add_u32 m0, s51, 148992
  s_mov_b32 s50, 313344
  buffer_load_dwordx4 v139, s[28:31], s50 offen lds
  s_barrier
  s_add_u32 m0, s92, 102400
  s_add_u32 s50, s95, 1024
  buffer_load_dwordx4 v131, s[24:27], s50 offen lds
  s_add_u32 m0, s92, 106496
  s_add_u32 s50, s95, 37888
  buffer_load_dwordx4 v131, s[24:27], s50 offen lds
  s_add_u32 m0, s51, 152064
  s_mov_b32 s50, 396288
  buffer_load_dwordx4 v139, s[28:31], s50 offen lds
  s_add_u32 m0, s51, 155136
  s_mov_b32 s50, 479232
  buffer_load_dwordx4 v139, s[28:31], s50 offen lds
  s_barrier
  s_add_u32 m0, s92, 110592
  s_add_u32 s50, s95, 74752
  buffer_load_dwordx4 v131, s[24:27], s50 offen lds
  s_add_u32 m0, s92, 0
  s_add_u32 s50, s95, 0
  buffer_load_dwordx4 v131, s[24:27], s50 offen lds
  s_add_u32 m0, s92, 4096
  s_add_u32 s50, s95, 36864
  buffer_load_dwordx4 v131, s[24:27], s50 offen lds
  s_add_u32 m0, s51, 158208
  s_mov_b32 s50, 562176
  buffer_load_dwordx4 v139, s[28:31], s50 offen lds
  s_add_u32 m0, s51, 115200
  s_mov_b32 s50, 9216
  buffer_load_dwordx4 v139, s[28:31], s50 offen lds
  s_waitcnt vmcnt(14)
  s_barrier
  s_add_u32 m0, s92, 8192
  s_add_u32 s50, s95, 73728
  buffer_load_dwordx4 v131, s[24:27], s50 offen lds
  s_add_u32 m0, s51, 118272
  s_mov_b32 s50, 92160
  buffer_load_dwordx4 v139, s[28:31], s50 offen lds
  s_add_u32 m0, s51, 121344
  s_mov_b32 s50, 175104
  buffer_load_dwordx4 v139, s[28:31], s50 offen lds
  s_waitcnt vmcnt(7)
  s_barrier
  s_add_u32 m0, s51, 124416
  s_mov_b32 s50, 258048
  buffer_load_dwordx4 v139, s[28:31], s50 offen lds
  s_add_u32 m0, s51, 127488
  s_mov_b32 s50, 340992
  buffer_load_dwordx4 v139, s[28:31], s50 offen lds
  s_barrier
  s_add_u32 m0, s51, 130560
  s_mov_b32 s50, 423936
  buffer_load_dwordx4 v139, s[28:31], s50 offen lds
  s_add_u32 m0, s51, 133632
  s_mov_b32 s50, 506880
  buffer_load_dwordx4 v139, s[28:31], s50 offen lds
  s_barrier
  s_add_u32 m0, s51, 136704
  s_mov_b32 s50, 589824
  buffer_load_dwordx4 v139, s[28:31], s50 offen lds
  s_add_u32 m0, s51, 139776
  s_mov_b32 s50, 73728
  buffer_load_dwordx4 v139, s[28:31], s50 offen lds
  s_waitcnt vmcnt(10)
  s_barrier
  s_add_u32 m0, s51, 142848
  s_mov_b32 s50, 156672
  buffer_load_dwordx4 v139, s[28:31], s50 offen lds
  s_add_u32 m0, s51, 145920
  s_mov_b32 s50, 239616
  buffer_load_dwordx4 v139, s[28:31], s50 offen lds
  s_waitcnt vmcnt(9)
  s_barrier
  s_add_u32 m0, s51, 148992
  s_mov_b32 s50, 322560
  buffer_load_dwordx4 v139, s[28:31], s50 offen lds
  s_add_u32 m0, s51, 152064
  s_mov_b32 s50, 405504
  buffer_load_dwordx4 v139, s[28:31], s50 offen lds
  s_waitcnt vmcnt(9)
  s_barrier
  s_add_u32 m0, s92, 51200
  s_add_u32 s50, s95, 512
  buffer_load_dwordx4 v131, s[24:27], s50 offen lds
  s_add_u32 m0, s92, 55296
  s_add_u32 s50, s95, 37376
  buffer_load_dwordx4 v131, s[24:27], s50 offen lds
  s_add_u32 m0, s92, 59392
  s_add_u32 s50, s95, 74240
  buffer_load_dwordx4 v131, s[24:27], s50 offen lds
  s_add_u32 m0, s51, 155136
  s_mov_b32 s50, 488448
  buffer_load_dwordx4 v139, s[28:31], s50 offen lds
  s_add_u32 m0, s51, 158208
  s_mov_b32 s50, 571392
  buffer_load_dwordx4 v139, s[28:31], s50 offen lds
  s_waitcnt vmcnt(12)
  s_barrier
  s_add_u32 m0, s51, 115200
  s_mov_b32 s50, 0
  buffer_load_dwordx4 v139, s[28:31], s50 offen lds
  s_add_u32 m0, s51, 118272
  s_mov_b32 s50, 82944
  buffer_load_dwordx4 v139, s[28:31], s50 offen lds
  s_waitcnt vmcnt(12)
  s_barrier
  s_add_u32 m0, s51, 121344
  s_mov_b32 s50, 165888
  buffer_load_dwordx4 v139, s[28:31], s50 offen lds
  s_add_u32 m0, s51, 124416
  s_mov_b32 s50, 248832
  buffer_load_dwordx4 v139, s[28:31], s50 offen lds
  s_waitcnt vmcnt(6)
  s_barrier
  s_add_u32 m0, s51, 127488
  s_mov_b32 s50, 331776
  buffer_load_dwordx4 v139, s[28:31], s50 offen lds
  s_add_u32 m0, s51, 130560
  s_mov_b32 s50, 414720
  buffer_load_dwordx4 v139, s[28:31], s50 offen lds
  s_barrier
  s_add_u32 m0, s51, 133632
  s_mov_b32 s50, 497664
  buffer_load_dwordx4 v139, s[28:31], s50 offen lds
  s_add_u32 m0, s51, 136704
  s_mov_b32 s50, 580608
  buffer_load_dwordx4 v139, s[28:31], s50 offen lds
  buffer_load_ushort v137, v134, s[52:55], 0 offen
  buffer_load_ushort v138, v134, s[56:59], 0 offen
  s_waitcnt vmcnt(9)
  s_barrier
  s_waitcnt vmcnt(5)
  s_barrier
  s_waitcnt vmcnt(2)
  s_barrier
  s_branch L_wepi
L_xmain1:
  s_barrier
  s_add_u32 m0, s81, 89600
  s_add_u32 s50, s84, 896
  buffer_load_dwordx4 v131, s[24:27], s50 offen lds
  s_add_u32 m0, s81, 92672
  s_add_u32 s50, s84, 28544
  buffer_load_dwordx4 v131, s[24:27], s50 offen lds
  s_add_u32 m0, s81, 95744
  s_add_u32 s50, s84, 56192
  buffer_load_dwordx4 v131, s[24:27], s50 offen lds
  s_add_u32 m0, s81, 98816
  s_add_u32 s50, s84, 83840
  buffer_load_dwordx4 v131, s[24:27], s50 offen lds
  s_barrier
  s_add_u32 m0, s82, 89600
  s_add_u32 s50, s85, 896
  buffer_load_dwordx4 v131, s[24:27], s50 offen lds
  s_add_u32 m0, s82, 92672
  s_add_u32 s50, s85, 28544
  buffer_load_dwordx4 v131, s[24:27], s50 offen lds
  s_add_u32 m0, s82, 95744
  s_add_u32 s50, s85, 56192
  buffer_load_dwordx4 v131, s[24:27], s50 offen lds
  s_add_u32 m0, s82, 98816
  s_add_u32 s50, s85, 83840
  buffer_load_dwordx4 v131, s[24:27], s50 offen lds
  s_barrier
  s_barrier
  s_waitcnt vmcnt(0)
  s_barrier
  s_barrier
  s_add_u32 m0, s92, 12800
  s_add_u32 s50, s95, 128
  buffer_load_dwordx4 v131, s[24:27], s50 offen lds
  s_add_u32 m0, s92, 16896
  s_add_u32 s50, s95, 36992
  buffer_load_dwordx4 v131, s[24:27], s50 offen lds
  s_add_u32 m0, s92, 20992
  s_add_u32 s50, s95, 73856
  buffer_load_dwordx4 v131, s[24:27], s50 offen lds
  s_mov_b32 m0, 25088
  s_mov_b32 s50, 110720
  s_mov_b32 exec_hi, 0
  buffer_load_dwordx4 v131, s[24:27], s50 offen lds
  s_mov_b32 exec_hi, -1
  s_barrier
  s_add_u32 m0, s92, 38400
  s_add_u32 s50, s95, 384
  buffer_load_dwordx4 v131, s[24:27], s50 offen lds
  s_add_u32 m0, s92, 42496
  s_add_u32 s50, s95, 37248
  buffer_load_dwordx4 v131, s[24:27], s50 offen lds
  s_add_u32 m0, s92, 46592
  s_add_u32 s50, s95, 74112
  buffer_load_dwordx4 v131, s[24:27], s50 offen lds
  s_mov_b32 m0, 50688
  s_mov_b32 s50, 110976
  s_mov_b32 exec_hi, 0
  buffer_load_dwordx4 v131, s[24:27], s50 offen lds
  s_mov_b32 exec_hi, -1
  s_barrier
  s_waitcnt vmcnt(4)
  s_barrier
  s_barrier
  s_barrier
  s_barrier
  s_waitcnt vmcnt(0)
  s_barrier
  s_add_u32 m0, s92, 64000
  s_add_u32 s50, s95, 640
  buffer_load_dwordx4 v131, s[24:27], s50 offen lds
  s_add_u32 m0, s92, 68096
  s_add_u32 s50, s95, 37504
  buffer_load_dwordx4 v131, s[24:27], s50 offen lds
  s_barrier
  s_add_u32 m0, s92, 72192
  s_add_u32 s50, s95, 74368
  buffer_load_dwordx4 v131, s[24:27], s50 offen lds
  s_mov_b32 m0, 76288
  s_mov_b32 s50, 111232
  s_mov_b32 exec_hi, 0
  buffer_load_dwordx4 v131, s[24:27], s50 offen lds
  s_mov_b32 exec_hi, -1
  s_barrier
  s_waitcnt vmcnt(0)
  s_barrier
  s_barrier
  s_add_u32 m0, s92, 102400
  s_add_u32 s50, s95, 1024
  buffer_load_dwordx4 v131, s[24:27], s50 offen lds
  s_add_u32 m0, s92, 106496
  s_add_u32 s50, s95, 37888
  buffer_load_dwordx4 v131, s[24:27], s50 offen lds
  s_barrier
  s_add_u32 m0, s92, 110592
  s_add_u32 s50, s95, 74752
  buffer_load_dwordx4 v131, s[24:27], s50 offen lds
  s_mov_b32 m0, 114688
  s_mov_b32 s50, 111616
  s_mov_b32 exec_hi, 0
  buffer_load_dwordx4 v131, s[24:27], s50 offen lds
  s_mov_b32 exec_hi, -1
  s_add_u32 m0, s92, 0
  s_add_u32 s50, s95, 0
  buffer_load_dwordx4 v131, s[24:27], s50 offen lds
  s_add_u32 m0, s92, 4096
  s_add_u32 s50, s95, 36864
  buffer_load_dwordx4 v131, s[24:27], s50 offen lds
  s_barrier
  s_add_u32 m0, s92, 8192
  s_add_u32 s50, s95, 73728
  buffer_load_dwordx4 v131, s[24:27], s50 offen lds
  s_mov_b32 m0, 12288
  s_mov_b32 s50, 110592
  s_mov_b32 exec_hi, 0
  buffer_load_dwordx4 v131, s[24:27], s50 offen lds
  s_mov_b32 exec_hi, -1
  s_waitcnt vmcnt(4)
  s_barrier
  s_barrier
  s_barrier
  s_barrier
  s_waitcnt vmcnt(0)
  s_barrier
  s_barrier
  s_add_u32 m0, s92, 51200
  s_add_u32 s50, s95, 512
  buffer_load_dwordx4 v131, s[24:27], s50 offen lds
  s_add_u32 m0, s92, 55296
  s_add_u32 s50, s95, 37376
  buffer_load_dwordx4 v131, s[24:27], s50 offen lds
  s_add_u32 m0, s92, 59392
  s_add_u32 s50, s95, 74240
  buffer_load_dwordx4 v131, s[24:27], s50 offen lds
  s_mov_b32 m0, 63488
  s_mov_b32 s50, 111104
  s_mov_b32 exec_hi, 0
  buffer_load_dwordx4 v131, s[24:27], s50 offen lds
  s_mov_b32 exec_hi, -1
  s_barrier
  s_barrier
  s_waitcnt vmcnt(0)
  s_barrier
  s_barrier
  s_branch L_xtail
L_wmain2:
  s_waitcnt vmcnt(1)
  s_add_u32 m0, s51, 121344
  s_mov_b32 s50, 202752
  buffer_load_dwordx4 v139, s[28:31], s50 offen lds
  s_add_u32 m0, s51, 124416
  s_mov_b32 s50, 285696
  buffer_load_dwordx4 v139, s[28:31], s50 offen lds
  s_barrier
  s_add_u32 m0, s51, 127488
  s_mov_b32 s50, 368640
  buffer_load_dwordx4 v139, s[28:31], s50 offen lds
  s_add_u32 m0, s51, 130560
  s_mov_b32 s50, 451584
  buffer_load_dwordx4 v139, s[28:31], s50 offen lds
  s_add_u32 m0, s51, 133632
  s_mov_b32 s50, 534528
  buffer_load_dwordx4 v139, s[28:31], s50 offen lds
  s_waitcnt vmcnt(4)
  s_barrier
  s_add_u32 m0, s51, 136704
  s_mov_b32 s50, 617472
  buffer_load_dwordx4 v139, s[28:31], s50 offen lds
  s_add_u32 m0, s51, 139776
  s_mov_b32 s50, 46080
  buffer_load_dwordx4 v139, s[28:31], s50 offen lds
  s_add_u32 m0, s51, 142848
  s_mov_b32 s50, 129024
  buffer_load_dwordx4 v139, s[28:31], s50 offen lds
  s_add_u32 m0, s51, 145920
  s_mov_b32 s50, 211968
  buffer_load_dwordx4 v139, s[28:31], s50 offen lds
  s_add_u32 m0, s51, 148992
  s_mov_b32 s50, 294912
  buffer_load_dwordx4 v139, s[28:31], s50 offen lds
  s_waitcnt vmcnt(7)
  s_barrier
  s_add_u32 m0, s51, 152064
  s_mov_b32 s50, 377856
  buffer_load_dwordx4 v139, s[28:31], s50 offen lds
  s_add_u32 m0, s51, 155136
  s_mov_b32 s50, 460800
  buffer_load_dwordx4 v139, s[28:31], s50 offen lds
  s_add_u32 m0, s51, 158208
  s_mov_b32 s50, 543744
  buffer_load_dwordx4 v139, s[28:31], s50 offen lds
  s_add_u32 m0, s51, 115200
  s_mov_b32 s50, 27648
  buffer_load_dwordx4 v139, s[28:31], s50 offen lds
  s_waitcnt vmcnt(9)
  s_barrier
  s_add_u32 m0, s51, 118272
  s_mov_b32 s50, 110592
  buffer_load_dwordx4 v139, s[28:31], s50 offen lds
  s_add_u32 m0, s51, 121344
  s_mov_b32 s50, 193536
  buffer_load_dwordx4 v139, s[28:31], s50 offen lds
  s_waitcnt vmcnt(9)
  s_barrier
  s_add_u32 m0, s51, 124416
  s_mov_b32 s50, 276480
  buffer_load_dwordx4 v139, s[28:31], s50 offen lds
  s_add_u32 m0, s51, 127488
  s_mov_b32 s50, 359424
  buffer_load_dwordx4 v139, s[28:31], s50 offen lds
  s_waitcnt vmcnt(9)
  s_barrier
  s_add_u32 m0, s92, 12800
  s_add_u32 s50, s95, 128
  buffer_load_dwordx4 v131, s[24:27], s50 offen lds
  s_add_u32 m0, s92, 16896
  s_add_u32 s50, s95, 36992
  buffer_load_dwordx4 v131, s[24:27], s50 offen lds
  s_add_u32 m0, s92, 20992
  s_add_u32 s50, s95, 73856
  buffer_load_dwordx4 v131, s[24:27], s50 offen lds
  s_add_u32 m0, s51, 130560
  s_mov_b32 s50, 442368
  buffer_load_dwordx4 v139, s[28:31], s50 offen lds
  s_add_u32 m0, s51, 133632
  s_mov_b32 s50, 525312
  buffer_load_dwordx4 v139, s[28:31], s50 offen lds
  s_waitcnt vmcnt(12)
  s_barrier
  s_add_u32 m0, s51, 136704
  s_mov_b32 s50, 608256
  buffer_load_dwordx4 v139, s[28:31], s50 offen lds
  s_add_u32 m0, s51, 139776
  s_mov_b32 s50, 55296
  buffer_load_dwordx4 v139, s[28:31], s50 offen lds
  s_waitcnt vmcnt(12)
  s_barrier
  s_add_u32 m0, s51, 142848
  s_mov_b32 s50, 138240
  buffer_load_dwordx4 v139, s[28:31], s50 offen lds
  s_add_u32 m0, s51, 145920
  s_mov_b32 s50, 221184
  buffer_load_dwordx4 v139, s[28:31], s50 offen lds
  s_waitcnt vmcnt(6)
  s_barrier
  s_add_u32 m0, s51, 148992
  s_mov_b32 s50, 304128
  buffer_load_dwordx4 v139, s[28:31], s50 offen lds
  s_add_u32 m0, s51, 152064
  s_mov_b32 s50, 387072
  buffer_load_dwordx4 v139, s[28:31], s50 offen lds
  s_barrier
  s_add_u32 m0, s92, 38400
  s_add_u32 s50, s95, 384
  buffer_load_dwordx4 v131, s[24:27], s50 offen lds
  s_add_u32 m0, s92, 42496
  s_add_u32 s50, s95, 37248
  buffer_load_dwordx4 v131, s[24:27], s50 offen lds
  s_add_u32 m0, s92, 46592
  s_add_u32 s50, s95, 74112
  buffer_load_dwordx4 v131, s[24:27], s50 offen lds
  s_add_u32 m0, s51, 155136
  s_mov_b32 s50, 470016
  buffer_load_dwordx4 v139, s[28:31], s50 offen lds
  s_add_u32 m0, s51, 158208
  s_mov_b32 s50, 552960
  buffer_load_dwordx4 v139, s[28:31], s50 offen lds
  s_waitcnt vmcnt(12)
  s_barrier
  s_add_u32 m0, s92, 64000
  s_add_u32 s50, s95, 640
  buffer_load_dwordx4 v131, s[24:27], s50 offen lds
  s_add_u32 m0, s92, 68096
  s_add_u32 s50, s95, 37504
  buffer_load_dwordx4 v131, s[24:27], s50 offen lds
  s_add_u32 m0, s92, 72192
  s_add_u32 s50, s95, 74368
  buffer_load_dwordx4 v131, s[24:27], s50 offen lds
  s_add_u32 m0, s51, 115200
  s_mov_b32 s50, 18432
  buffer_load_dwordx4 v139, s[28:31], s50 offen lds
  s_add_u32 m0, s51, 118272
  s_mov_b32 s50, 101376
  buffer_load_dwordx4 v139, s[28:31], s50 offen lds
  s_waitcnt vmcnt(15)
  s_barrier
  s_add_u32 m0, s51, 121344
  s_mov_b32 s50, 184320
  buffer_load_dwordx4 v139, s[28:31], s50 offen lds
  s_add_u32 m0, s51, 124416
  s_mov_b32 s50, 267264
  buffer_load_dwordx4 v139, s[28:31], s50 offen lds
  s_waitcnt vmcnt(9)
  s_barrier
  s_add_u32 m0, s51, 127488
  s_mov_b32 s50, 350208
  buffer_load_dwordx4 v139, s[28:31], s50 offen lds
  s_add_u32 m0, s51, 130560
  s_mov_b32 s50, 433152
  buffer_load_dwordx4 v139, s[28:31], s50 offen lds
  s_barrier
  s_add_u32 m0, s51, 133632
  s_mov_b32 s50, 516096
  buffer_load_dwordx4 v139, s[28:31], s50 offen lds
  s_add_u32 m0, s51, 136704
  s_mov_b32 s50, 599040
  buffer_load_dwordx4 v139, s[28:31], s50 offen lds
  s_waitcnt vmcnt(12)
  s_barrier
  s_add_u32 m0, s51, 139776
  s_mov_b32 s50, 64512
  buffer_load_dwordx4 v139, s[28:31], s50 offen lds
  s_add_u32 m0, s51, 142848
  s_mov_b32 s50, 147456
  buffer_load_dwordx4 v139, s[28:31], s50 offen lds
  s_waitcnt vmcnt(9)
  s_barrier
  s_add_u32 m0, s51, 145920
  s_mov_b32 s50, 230400
  buffer_load_dwordx4 v139, s[28:31], s50 offen lds
  s_add_u32 m0, s51, 148992
  s_mov_b32 s50, 313344
  buffer_load_dwordx4 v139, s[28:31], s50 offen lds
  s_waitcnt vmcnt(9)
  s_barrier
  s_add_u32 m0, s92, 102400
  s_add_u32 s50, s95, 1024
  buffer_load_dwordx4 v131, s[24:27], s50 offen lds
  s_add_u32 m0, s92, 106496
  s_add_u32 s50, s95, 37888
  buffer_load_dwordx4 v131, s[24:27], s50 offen lds
  s_add_u32 m0, s51, 152064
  s_mov_b32 s50, 396288
  buffer_load_dwordx4 v139, s[28:31], s50 offen lds
  s_add_u32 m0, s51, 155136
  s_mov_b32 s50, 479232
  buffer_load_dwordx4 v139, s[28:31], s50 offen lds
  s_waitcnt vmcnt(11)
  s_barrier
  s_add_u32 m0, s92, 110592
  s_add_u32 s50, s95, 74752
  buffer_load_dwordx4 v131, s[24:27], s50 offen lds
  s_add_u32 m0, s51, 158208
  s_mov_b32 s50, 562176
  buffer_load_dwordx4 v139, s[28:31], s50 offen lds
  s_add_u32 m0, s51, 115200
  s_mov_b32 s50, 9216
  buffer_load_dwordx4 v139, s[28:31], s50 offen lds
  s_waitcnt vmcnt(12)
  s_barrier
  s_add_u32 m0, s51, 118272
  s_mov_b32 s50, 92160
  buffer_load_dwordx4 v139, s[28:31], s50 offen lds
  s_add_u32 m0, s51, 121344
  s_mov_b32 s50, 175104
  buffer_load_dwordx4 v139, s[28:31], s50 offen lds
  s_waitcnt vmcnt(4)
  s_barrier
  s_add_u32 m0, s51, 124416
  s_mov_b32 s50, 258048
  buffer_load_dwordx4 v139, s[28:31], s50 offen lds
  s_add_u32 m0, s51, 127488
  s_mov_b32 s50, 340992
  buffer_load_dwordx4 v139, s[28:31], s50 offen lds
  s_barrier
  s_add_u32 m0, s92, 0
  s_add_u32 s50, s95, 0
  buffer_load_dwordx4 v131, s[24:27], s50 offen lds
  s_add_u32 m0, s92, 4096
  s_add_u32 s50, s95, 36864
  buffer_load_dwordx4 v131, s[24:27], s50 offen lds
  s_add_u32 m0, s92, 8192
  s_add_u32 s50, s95, 73728
  buffer_load_dwordx4 v131, s[24:27], s50 offen lds
  s_add_u32 m0, s51, 130560
  s_mov_b32 s50, 423936
  buffer_load_dwordx4 v139, s[28:31], s50 offen lds
  s_add_u32 m0, s51, 133632
  s_mov_b32 s50, 506880
  buffer_load_dwordx4 v139, s[28:31], s50 offen lds
  s_barrier
  s_add_u32 m0, s92, 51200
  s_add_u32 s50, s95, 512
  buffer_load_dwordx4 v131, s[24:27], s50 offen lds
  s_add_u32 m0, s92, 55296
  s_add_u32 s50, s95, 37376
  buffer_load_dwordx4 v131, s[24:27], s50 offen lds
  s_add_u32 m0, s92, 59392
  s_add_u32 s50, s95, 74240
  buffer_load_dwordx4 v131, s[24:27], s50 offen lds
  s_add_u32 m0, s51, 136704
  s_mov_b32 s50, 589824
  buffer_load_dwordx4 v139, s[28:31], s50 offen lds
  s_add_u32 m0, s51, 139776
  s_mov_b32 s50, 73728
  buffer_load_dwordx4 v139, s[28:31], s50 offen lds
  s_waitcnt vmcnt(15)
  s_barrier
  s_add_u32 m0, s51, 142848
  s_mov_b32 s50, 156672
  buffer_load_dwordx4 v139, s[28:31], s50 offen lds
  s_add_u32 m0, s51, 145920
  s_mov_b32 s50, 239616
  buffer_load_dwordx4 v139, s[28:31], s50 offen lds
  s_waitcnt vmcnt(9)
  s_barrier
  s_add_u32 m0, s51, 148992
  s_mov_b32 s50, 322560
  buffer_load_dwordx4 v139, s[28:31], s50 offen lds
  s_add_u32 m0, s51, 152064
  s_mov_b32 s50, 405504
  buffer_load_dwordx4 v139, s[28:31], s50 offen lds
  s_barrier
  s_add_u32 m0, s51, 155136
  s_mov_b32 s50, 488448
  buffer_load_dwordx4 v139, s[28:31], s50 offen lds
  s_add_u32 m0, s51, 158208
  s_mov_b32 s50, 571392
  buffer_load_dwordx4 v139, s[28:31], s50 offen lds
  s_waitcnt vmcnt(12)
  s_barrier
  s_add_u32 m0, s51, 115200
  s_mov_b32 s50, 0
  buffer_load_dwordx4 v139, s[28:31], s50 offen lds
  s_add_u32 m0, s51, 118272
  s_mov_b32 s50, 82944
  buffer_load_dwordx4 v139, s[28:31], s50 offen lds
  s_waitcnt vmcnt(9)
  s_barrier
  s_add_u32 m0, s51, 121344
  s_mov_b32 s50, 165888
  buffer_load_dwordx4 v139, s[28:31], s50 offen lds
  s_add_u32 m0, s51, 124416
  s_mov_b32 s50, 248832
  buffer_load_dwordx4 v139, s[28:31], s50 offen lds
  s_waitcnt vmcnt(7)
  s_barrier
  s_add_u32 m0, s51, 127488
  s_mov_b32 s50, 331776
  buffer_load_dwordx4 v139, s[28:31], s50 offen lds
  s_add_u32 m0, s51, 130560
  s_mov_b32 s50, 414720
  buffer_load_dwordx4 v139, s[28:31], s50 offen lds
  s_barrier
  s_add_u32 m0, s51, 133632
  s_mov_b32 s50, 497664
  buffer_load_dwordx4 v139, s[28:31], s50 offen lds
  s_add_u32 m0, s51, 136704
  s_mov_b32 s50, 580608
  buffer_load_dwordx4 v139, s[28:31], s50 offen lds
  buffer_load_ushort v137, v134, s[52:55], 0 offen
  buffer_load_ushort v138, v134, s[56:59], 0 offen
  s_waitcnt vmcnt(9)
  s_barrier
  s_waitcnt vmcnt(5)
  s_barrier
  s_waitcnt vmcnt(2)
  s_barrier
  s_branch L_wepi
L_xmain2:
  s_barrier
  s_add_u32 m0, s81, 89600
  s_add_u32 s50, s84, 896
  buffer_load_dwordx4 v131, s[24:27], s50 offen lds
  s_add_u32 m0, s81, 92672
  s_add_u32 s50, s84, 28544
  buffer_load_dwordx4 v131, s[24:27], s50 offen lds
  s_add_u32 m0, s81, 95744
  s_add_u32 s50, s84, 56192
  buffer_load_dwordx4 v131, s[24:27], s50 offen lds
  s_add_u32 m0, s81, 98816
  s_add_u32 s50, s84, 83840
  buffer_load_dwordx4 v131, s[24:27], s50 offen lds
  s_barrier
  s_add_u32 m0, s82, 89600
  s_add_u32 s50, s85, 896
  buffer_load_dwordx4 v131, s[24:27], s50 offen lds
  s_add_u32 m0, s82, 92672
  s_add_u32 s50, s85, 28544
  buffer_load_dwordx4 v131, s[24:27], s50 offen lds
  s_add_u32 m0, s82, 95744
  s_add_u32 s50, s85, 56192
  buffer_load_dwordx4 v131, s[24:27], s50 offen lds
  s_add_u32 m0, s82, 98816
  s_add_u32 s50, s85, 83840
  buffer_load_dwordx4 v131, s[24:27], s50 offen lds
  s_barrier
  s_barrier
  s_waitcnt vmcnt(0)
  s_barrier
  s_barrier
  s_add_u32 m0, s92, 12800
  s_add_u32 s50, s95, 128
  buffer_load_dwordx4 v131, s[24:27], s50 offen lds
  s_add_u32 m0, s92, 16896
  s_add_u32 s50, s95, 36992
  buffer_load_dwordx4 v131, s[24:27], s50 offen lds
  s_add_u32 m0, s92, 20992
  s_add_u32 s50, s95, 73856
  buffer_load_dwordx4 v131, s[24:27], s50 offen lds
  s_mov_b32 m0, 25088
  s_mov_b32 s50, 110720
  s_mov_b32 exec_hi, 0
  buffer_load_dwordx4 v131, s[24:27], s50 offen lds
  s_mov_b32 exec_hi, -1
  s_barrier
  s_barrier
  s_waitcnt vmcnt(0)
  s_barrier
  s_barrier
  s_add_u32 m0, s92, 38400
  s_add_u32 s50, s95, 384
  buffer_load_dwordx4 v131, s[24:27], s50 offen lds
  s_add_u32 m0, s92, 42496
  s_add_u32 s50, s95, 37248
  buffer_load_dwordx4 v131, s[24:27], s50 offen lds
  s_add_u32 m0, s92, 46592
  s_add_u32 s50, s95, 74112
  buffer_load_dwordx4 v131, s[24:27], s50 offen lds
  s_mov_b32 m0, 50688
  s_mov_b32 s50, 110976
  s_mov_b32 exec_hi, 0
  buffer_load_dwordx4 v131, s[24:27], s50 offen lds
  s_mov_b32 exec_hi, -1
  s_barrier
  s_add_u32 m0, s92, 64000
  s_add_u32 s50, s95, 640
  buffer_load_dwordx4 v131, s[24:27], s50 offen lds
  s_add_u32 m0, s92, 68096
  s_add_u32 s50, s95, 37504
  buffer_load_dwordx4 v131, s[24:27], s50 offen lds
  s_add_u32 m0, s92, 72192
  s_add_u32 s50, s95, 74368
  buffer_load_dwordx4 v131, s[24:27], s50 offen lds
  s_mov_b32 m0, 76288
  s_mov_b32 s50, 111232
  s_mov_b32 exec_hi, 0
  buffer_load_dwordx4 v131, s[24:27], s50 offen lds
  s_mov_b32 exec_hi, -1
  s_barrier
  s_waitcnt vmcnt(4)
  s_barrier
  s_barrier
  s_barrier
  s_waitcnt vmcnt(0)
  s_barrier
  s_barrier
  s_add_u32 m0, s92, 102400
  s_add_u32 s50, s95, 1024
  buffer_load_dwordx4 v131, s[24:27], s50 offen lds
  s_add_u32 m0, s92, 106496
  s_add_u32 s50, s95, 37888
  buffer_load_dwordx4 v131, s[24:27], s50 offen lds
  s_barrier
  s_add_u32 m0, s92, 110592
  s_add_u32 s50, s95, 74752
  buffer_load_dwordx4 v131, s[24:27], s50 offen lds
  s_mov_b32 m0, 114688
  s_mov_b32 s50, 111616
  s_mov_b32 exec_hi, 0
  buffer_load_dwordx4 v131, s[24:27], s50 offen lds
  s_mov_b32 exec_hi, -1
  s_barrier
  s_waitcnt vmcnt(0)
  s_barrier
  s_barrier
  s_add_u32 m0, s92, 0
  s_add_u32 s50, s95, 0
  buffer_load_dwordx4 v131, s[24:27], s50 offen lds
  s_add_u32 m0, s92, 4096
  s_add_u32 s50, s95, 36864
  buffer_load_dwordx4 v131, s[24:27], s50 offen lds
  s_add_u32 m0, s92, 8192
  s_add_u32 s50, s95, 73728
  buffer_load_dwordx4 v131, s[24:27], s50 offen lds
  s_mov_b32 m0, 12288
  s_mov_b32 s50, 110592
  s_mov_b32 exec_hi, 0
  buffer_load_dwordx4 v131, s[24:27], s50 offen lds
  s_mov_b32 exec_hi, -1
  s_barrier
  s_add_u32 m0, s92, 51200
  s_add_u32 s50, s95, 512
  buffer_load_dwordx4 v131, s[24:27], s50 offen lds
  s_add_u32 m0, s92, 55296
  s_add_u32 s50, s95, 37376
  buffer_load_dwordx4 v131, s[24:27], s50 offen lds
  s_add_u32 m0, s92, 59392
  s_add_u32 s50, s95, 74240
  buffer_load_dwordx4 v131, s[24:27], s50 offen lds
  s_mov_b32 m0, 63488
  s_mov_b32 s50, 111104
  s_mov_b32 exec_hi, 0
  buffer_load_dwordx4 v131, s[24:27], s50 offen lds
  s_mov_b32 exec_hi, -1
  s_barrier
  s_waitcnt vmcnt(4)
  s_barrier
  s_barrier
  s_barrier
  s_barrier
  s_waitcnt vmcnt(0)
  s_barrier
  s_barrier
L_xtail:
  s_lshl_b32 s44, s23, 5
  v_mov_b32 v140, s44
  global_load_dword v142, v140, s[14:15] sc1
  s_getpc_b64 s[56:57]
L_pc:
  s_sub_u32 s56, s56, L_pc-L_epi
  s_subb_u32 s57, s57, 0
  s_and_b32 s56, s56, 0xffffff80
  s_mov_b32 s58, L_epi_end-L_epi+128
  s_mov_b32 s59, 0x20000
  v_lshlrev_b32 v147, 7, v129
  buffer_load_dword v148, v147, s[56:59], 0 offen
  s_barrier
  s_barrier
  s_barrier
  s_mov_b32 s45, 0
L_cnt_wait:
  s_waitcnt vmcnt(0)
  v_readfirstlane_b32 s44, v142
  s_add_u32 s45, s45, 1
  s_cmp_ge_u32 s44, 42
  s_cbranch_scc1 L_cnt_ok
  s_cmp_ge_u32 s45, 0x100000
  s_cbranch_scc1 L_cnt_ok
  global_load_dword v142, v140, s[14:15] sc1
  s_branch L_cnt_wait
L_cnt_ok:
  s_barrier
L_end:
  s_endpgm
.section .rodata,"a"
.p2align 6
.amdhsa_kernel standalone__self_sup_conv_stem_wavlm__speech_kernel
  .amdhsa_next_free_vgpr 256
  .amdhsa_next_free_sgpr 102
  .amdhsa_accum_offset 256
  .amdhsa_group_segment_fixed_size 0
  .amdhsa_kernarg_size 56
  .amdhsa_float_denorm_mode_32 3
  .amdhsa_user_sgpr_count 2
  .amdhsa_user_sgpr_kernarg_segment_ptr 1
  .amdhsa_system_sgpr_workgroup_id_x 1
.end_amdhsa_kernel
```
